```python
import torch

def _softmax(x, axis=-1):
    return torch.softmax(x, dim=axis)
def _gelu(x):
    return torch.nn.functional.gelu(x, approximate="tanh")
def _silu(x):
    return torch.nn.functional.silu(x)
def _sigmoid(x):
    return torch.sigmoid(x)
def _layernorm(x, axis=-1, eps=1e-5):
    m = x.mean(dim=axis, keepdim=True)
    v = x.var(dim=axis, keepdim=True, unbiased=False)
    return (x - m) / torch.sqrt(v + eps)
def _scatter_add(tgt, idx, src, axis=0):
    return tgt.clone().index_add_(axis, idx, src)
def _segment_sum(src, seg, n):
    out = torch.zeros((n,) + src.shape[1:], dtype=src.dtype)
    return out.index_add_(0, seg, src)
def _pad(x, pw):
    flat = tuple(v for pair in reversed(pw) for v in pair)
    return torch.nn.functional.pad(x, flat)

kernel_name = 'gated_mix__ssm_conv_s5__dense_activation_mish__prompt'

def setup_inputs():

    _w = (lambda a: (lambda t: t.to(torch.bfloat16) if t.is_floating_point() else t)(torch.as_tensor(a)))
    def _A_setup():
        B, S, D = 1, 2048, 512
        P = D
        Lambda_re = -0.5 * (lambda _x: torch.exp(torch.as_tensor(_x)))((lambda *s: torch.randn(*s, dtype=torch.bfloat16) * 0.2)(P))
        Lambda_im = (lambda *s: torch.randn(*s, dtype=torch.bfloat16) * 0.2)(P) * 1.0
        B_re = (lambda *s: torch.randn(*s, dtype=torch.bfloat16) * 0.2)(P, D) * (D ** -0.5)
        B_im = (lambda *s: torch.randn(*s, dtype=torch.bfloat16) * 0.2)(P, D) * (D ** -0.5)
        C_re = (lambda *s: torch.randn(*s, dtype=torch.bfloat16) * 0.2)(D, P) * (P ** -0.5)
        C_im = (lambda *s: torch.randn(*s, dtype=torch.bfloat16) * 0.2)(D, P) * (P ** -0.5)
        log_dt = (lambda *s: torch.randn(*s, dtype=torch.bfloat16) * 0.2)(P) * 0.3 - 2.0
        Dskip = (lambda *s: torch.randn(*s, dtype=torch.bfloat16) * 0.05)(D)
        return {
            "x": _w((lambda *s: torch.randn(*s, dtype=torch.bfloat16) * 0.05)(B, S, D)),
            "Lambda_re": _w(Lambda_re),
            "Lambda_im": _w(Lambda_im),
            "B_re": _w(B_re),
            "B_im": _w(B_im),
            "C_re": _w(C_re),
            "C_im": _w(C_im),
            "log_dt": _w(log_dt),
            "Dskip": _w(Dskip),
        }
    _A_in = _A_setup()

    def _B_setup():
        B, S, D, F = 1, 2048, 512, 1792
        return {
            "x": _w((lambda *s: torch.randn(*s, dtype=torch.bfloat16) * 0.05)(B, S, D)),
            "w1": _w((lambda *s: torch.randn(*s, dtype=torch.bfloat16) * 3.2)(D, F) * (D ** -0.5)),
            "b1": _w((lambda *s: torch.randn(*s, dtype=torch.bfloat16) * 0.05)(F)),
            "w2": _w((lambda *s: torch.randn(*s, dtype=torch.bfloat16) * 0.05)(F, D) * (F ** -0.5)),
        }
    _B_in = _B_setup()

    return {
        "A_x": _A_in["x"],
        "A_Lambda_re": _A_in["Lambda_re"],
        "A_Lambda_im": _A_in["Lambda_im"],
        "A_B_re": _A_in["B_re"],
        "A_B_im": _A_in["B_im"],
        "A_C_re": _A_in["C_re"],
        "A_C_im": _A_in["C_im"],
        "A_log_dt": _A_in["log_dt"],
        "A_Dskip": _A_in["Dskip"],
        "B_x": _B_in["x"],
        "B_w1": _B_in["w1"],
        "B_b1": _B_in["b1"],
        "B_w2": _B_in["w2"],
        "gate_w": _w((lambda *s: torch.randn(*s, dtype=torch.bfloat16) * 0.05)(512) * 16.0),
    }

def reference(A_x, A_Lambda_re, A_Lambda_im, A_B_re, A_B_im, A_C_re, A_C_im, A_log_dt, A_Dskip, B_x, B_w1, B_b1, B_w2, gate_w):
    def _A_ref(x, Lambda_re, Lambda_im, B_re, B_im, C_re, C_im, log_dt, Dskip):
        Bsz, L, H = x.shape
        Lam = Lambda_re + 1j * Lambda_im
        Bmat = B_re + 1j * B_im
        Cmat = C_re + 1j * C_im
        dt = torch.exp(log_dt)
        Lam_bar = torch.exp(dt * Lam)
        B_bar = ((Lam_bar - 1.0) / Lam)[:, None] * Bmat
        Bu = torch.einsum("bld,pd->blp", x + 0j, B_bar)
        h = torch.zeros_like(Bu[:, 0, :])
        hs = []
        for t in range(L):
            h = Lam_bar[None, :] * h + Bu[:, t, :]
            hs.append(h)
        hseq = torch.stack(hs, 1)
        y = 2.0 * torch.einsum("blp,dp->bld", hseq, Cmat).real + x * Dskip[None, None, :]
        return y

    def _B_ref(x, w1, b1, w2):
        h = torch.einsum("bsd,df->bsf", x, w1) + b1
        sp = torch.log1p(torch.exp(-torch.abs(h))) + torch.where(h > 0, h, torch.zeros_like(h))
        act = h * torch.tanh(sp)
        return torch.einsum("bsf,fd->bsd", act, w2)

    x = A_x
    g = _sigmoid((x * gate_w).sum(-1, keepdims=True))
    a = _A_ref(x, A_Lambda_re, A_Lambda_im, A_B_re, A_B_im, A_C_re, A_C_im, A_log_dt, A_Dskip)
    b = _B_ref(x, B_w1, B_b1, B_w2)
    return g * a + (1 - g) * b
```

```asm
; @launch grid=(256,1,1) block=(512,1,1) lds=163840
.amdgcn_target "amdgcn-amd-amdhsa--gfx950"
.text
.globl gated_mix__ssm_conv_s5__dense_activation_mish__prompt_kernel
.p2align 8
.type gated_mix__ssm_conv_s5__dense_activation_mish__prompt_kernel,@function
gated_mix__ssm_conv_s5__dense_activation_mish__prompt_kernel:
    s_cmp_ge_u32 s2, 256
    s_cbranch_scc1 L_end
    s_load_dwordx4 s[4:7], s[0:1], 0
    s_load_dwordx4 s[8:11], s[0:1], 16
    s_load_dwordx4 s[12:15], s[0:1], 32
    s_load_dwordx4 s[16:19], s[0:1], 48
    s_load_dwordx4 s[20:23], s[0:1], 80
    s_load_dwordx4 s[24:27], s[0:1], 96
    s_load_dwordx4 s[28:31], s[0:1], 120
    s_load_dwordx2 s[96:97], s[0:1], 64
    s_load_dwordx2 s[98:99], s[0:1], 112
    s_and_b32 s35, s2, 7
    s_lshr_b32 s36, s2, 3
    s_lshr_b32 s32, s35, 1
    s_lshl_b32 s32, s32, 2
    s_lshr_b32 s33, s36, 3
    s_add_u32 s32, s32, s33
    s_and_b32 s33, s35, 1
    s_lshl_b32 s33, s33, 3
    s_and_b32 s36, s36, 7
    s_add_u32 s33, s33, s36
    v_lshrrev_b32 v1, 6, v0
    v_and_b32 v0, 63, v0
    v_readfirstlane_b32 s34, v1
    s_getpc_b64 s[38:39]
L_pc:
    s_cmp_lt_u32 s2, 16
    s_cbranch_scc0 L_cpf_1
    s_cmp_lt_u32 s34, 3
    s_cbranch_scc0 L_cpf_1
    s_lshl_b32 s101, s34, 13
    v_lshlrev_b32 v1, 7, v0
    v_add_u32 v1, s101, v1
    v_min_u32 v1, L_end-L_pc, v1
    global_load_dword v233, v1, s[38:39]
L_cpf_1:
    s_cmp_ge_u32 s34, 4
    s_cbranch_scc0 L_consumer
    s_sub_u32 s37, s34, 4
    s_cmp_eq_u32 s37, 0
    s_cselect_b32 s66, 8192, 0
    s_cselect_b32 s67, 64, 16
    s_cmp_eq_u32 s37, 2
    s_cselect_b32 s66, 7168, s66
    s_cselect_b32 s67, 56, s67
    s_bitcmp1_b32 s37, 0
    s_cselect_b32 s66, 2048, s66
    s_mul_i32 s66, s66, s2
    v_lshlrev_b32 v20, 7, v0
    v_add_u32 v20, s66, v20
    v_cmp_gt_u32 vcc, s67, v0
    s_waitcnt lgkmcnt(0)
    s_cmp_eq_u32 s37, 1
    s_cselect_b32 s38, s10, s4
    s_cselect_b32 s39, s11, s5
    s_cmp_eq_u32 s37, 2
    s_cselect_b32 s38, s20, s38
    s_cselect_b32 s39, s21, s39
    s_cmp_eq_u32 s37, 3
    s_cselect_b32 s38, s12, s38
    s_cselect_b32 s39, s13, s39
    s_mov_b64 exec, vcc
    global_load_dword v221, v20, s[38:39]
    s_mov_b64 exec, -1
    v_lshrrev_b32 v12, 3, v0
    v_and_b32 v13, 7, v0
    v_lshrrev_b32 v14, 4, v0
    s_lshl_b32 s38, s37, 15
    v_lshlrev_b32 v16, 10, v12
    v_add_u32 v16, s38, v16
    v_and_b32 v15, 1, v14
    v_xor_b32 v15, v13, v15
    v_xor_b32 v17, 0, v15
    v_lshl_add_u32 v17, v17, 4, v16
    v_add_u32 v4, 0, v17
    v_xor_b32 v17, 2, v15
    v_lshl_add_u32 v17, v17, 4, v16
    v_add_u32 v5, 7168, v17
    v_xor_b32 v17, 4, v15
    v_lshl_add_u32 v17, v17, 4, v16
    v_add_u32 v6, 14336, v17
    v_xor_b32 v17, 6, v15
    v_lshl_add_u32 v17, v17, 4, v16
    v_add_u32 v7, 21504, v17
    s_lshl_b32 s60, s32, 17
    s_lshl_b32 s63, s37, 12
    s_lshl_b32 s64, s37, 11
    s_waitcnt lgkmcnt(0)
    s_mov_b32 s44, s4
    s_and_b32 s45, s5, 0xffff
    s_mov_b32 s46, 2097152
    s_mov_b32 s47, 0x20000
    s_add_u32 m0, s63, 0
    s_nop 0
    buffer_load_dwordx4 v4, s[44:47], s60 offen offset:0 lds
    buffer_load_dwordx4 v5, s[44:47], s60 offen offset:1024 lds
    buffer_load_dwordx4 v6, s[44:47], s60 offen offset:2048 lds
    buffer_load_dwordx4 v7, s[44:47], s60 offen offset:3072 lds
    s_add_u32 s60, s60, 128
    s_lshl_b32 s38, s37, 4
    v_add_u32 v16, s38, v14
    v_mul_u32_u24 v16, 3584, v16
    v_and_b32 v15, 15, v0
    v_lshlrev_b32 v17, 1, v14
    v_xor_b32 v15, v15, v17
    v_mov_b32 v18, 0x7ff00000
    v_xor_b32 v17, 0, v15
    v_cmp_gt_u32 vcc, 14, v17
    v_lshl_add_u32 v17, v17, 4, v16
    s_nop 0
    v_cndmask_b32 v17, v18, v17, vcc
    v_add_u32 v124, 0, v17
    v_add_u32 v125, 13312, v17
    v_xor_b32 v17, 8, v15
    v_cmp_gt_u32 vcc, 14, v17
    v_lshl_add_u32 v17, v17, 4, v16
    s_nop 0
    v_cndmask_b32 v17, v18, v17, vcc
    v_add_u32 v126, 26624, v17
    v_add_u32 v127, 39936, v17
    s_mov_b32 s52, s20
    s_and_b32 s53, s21, 0xffff
    s_mov_b32 s54, 1835008
    s_mov_b32 s55, 0x20000
    s_mul_i32 s62, s33, 224
    s_add_u32 m0, s63, 73728
    s_nop 0
    buffer_load_dwordx4 v124, s[52:55], s62 offen offset:0 lds
    buffer_load_dwordx4 v125, s[52:55], s62 offen offset:1024 lds
    buffer_load_dwordx4 v126, s[52:55], s62 offen offset:2048 lds
    buffer_load_dwordx4 v127, s[52:55], s62 offen offset:3072 lds
    s_add_u32 s62, s62, 229376
    s_and_b32 s38, s37, 1
    s_lshl_b32 s38, s38, 14
    v_lshlrev_b32 v16, 10, v12
    v_add_u32 v16, s38, v16
    v_xor_b32 v15, v13, v14
    v_xor_b32 v17, 0, v15
    v_lshl_add_u32 v17, v17, 4, v16
    v_add_u32 v8, 0, v17
    v_xor_b32 v17, 4, v15
    v_lshl_add_u32 v17, v17, 4, v16
    v_add_u32 v9, 7168, v17
    s_cmp_ge_u32 s37, 2
    s_cselect_b32 s38, s12, s10
    s_cselect_b32 s39, s13, s11
    s_mov_b32 s48, s38
    s_and_b32 s49, s39, 0xffff
    s_mov_b32 s50, 524288
    s_mov_b32 s51, 0x20000
    s_lshl_b32 s61, s33, 15
    s_add_u32 m0, s64, 49152
    s_nop 0
    buffer_load_dwordx4 v8, s[48:51], s61 offen offset:0 lds
    buffer_load_dwordx4 v9, s[48:51], s61 offen offset:1024 lds
    s_add_u32 s61, s61, 128
    s_add_u32 m0, s63, 16384
    s_nop 0
    buffer_load_dwordx4 v4, s[44:47], s60 offen offset:0 lds
    buffer_load_dwordx4 v5, s[44:47], s60 offen offset:1024 lds
    buffer_load_dwordx4 v6, s[44:47], s60 offen offset:2048 lds
    buffer_load_dwordx4 v7, s[44:47], s60 offen offset:3072 lds
    s_add_u32 s60, s60, 128
    s_add_u32 m0, s63, 90112
    s_nop 0
    buffer_load_dwordx4 v124, s[52:55], s62 offen offset:0 lds
    buffer_load_dwordx4 v125, s[52:55], s62 offen offset:1024 lds
    buffer_load_dwordx4 v126, s[52:55], s62 offen offset:2048 lds
    buffer_load_dwordx4 v127, s[52:55], s62 offen offset:3072 lds
    s_add_u32 s62, s62, 229376
    s_add_u32 m0, s64, 57344
    s_nop 0
    buffer_load_dwordx4 v8, s[48:51], s61 offen offset:0 lds
    buffer_load_dwordx4 v9, s[48:51], s61 offen offset:1024 lds
    s_add_u32 s61, s61, 128
    s_mov_b32 s40, s30
    s_and_b32 s41, s31, 0xffff
    s_mov_b32 s42, 16777216
    s_mov_b32 s43, 0x20000
    s_mov_b32 s96, s28
    s_and_b32 s97, s29, 0xffff
    s_mov_b32 s98, 256
    s_mov_b32 s99, 0x20000
    s_cmp_eq_u32 s2, 0
    s_cbranch_scc0 L_nononce
    s_cmp_eq_u32 s37, 3
    s_cbranch_scc0 L_nononce
    s_memrealtime s[38:39]
    s_waitcnt lgkmcnt(0)
    s_or_b32 s38, s38, 1
    v_mov_b32 v20, s38
    v_mov_b32 v21, 0
    buffer_store_dword v20, v21, s[96:99], 0 offen sc1
L_nononce:
    v_mov_b32 v20, 0
    v_mov_b32 v21, 135172
    ds_write_b32 v21, v20
    ds_write_b32 v21, v20 offset:4
    ds_write_b32 v21, v20 offset:8
    ds_write_b32 v21, v20 offset:12
    ds_write_b32 v21, v20 offset:16
    ds_write_b32 v21, v20 offset:20
    ds_write_b32 v21, v20 offset:24
    s_lshr_b32 s38, s2, 3
    s_mul_i32 s39, s38, 56
    s_mul_i32 s66, s37, 14
    s_add_u32 s39, s39, s66
    s_lshl_b32 s39, s39, 10
    s_and_b32 s66, s2, 1
    s_lshl_b32 s67, s66, 9
    s_add_u32 s39, s39, s67
    s_add_u32 s88, s24, s39
    s_addc_u32 s89, s25, 0
    s_lshl_b32 s66, s66, 8
    s_lshl_b32 s38, s38, 3
    s_add_u32 s66, s66, s38
    s_and_b32 s38, s37, 1
    s_lshl_b32 s38, s38, 2
    s_add_u32 s66, s66, s38
    s_lshl_b32 s66, s66, 10
    s_cmp_ge_u32 s37, 2
    s_cselect_b32 s38, s16, s14
    s_cselect_b32 s39, s17, s15
    s_add_u32 s90, s38, s66
    s_addc_u32 s91, s39, 0
    s_waitcnt vmcnt(10) lgkmcnt(0)
    s_barrier
    s_add_u32 m0, s63, 32768
    s_nop 0
    buffer_load_dwordx4 v4, s[44:47], s60 offen offset:0 lds
    buffer_load_dwordx4 v5, s[44:47], s60 offen offset:1024 lds
    buffer_load_dwordx4 v6, s[44:47], s60 offen offset:2048 lds
    buffer_load_dwordx4 v7, s[44:47], s60 offen offset:3072 lds
    s_add_u32 s60, s60, 128
    s_add_u32 m0, s63, 106496
    s_nop 0
    buffer_load_dwordx4 v124, s[52:55], s62 offen offset:0 lds
    buffer_load_dwordx4 v125, s[52:55], s62 offen offset:1024 lds
    buffer_load_dwordx4 v126, s[52:55], s62 offen offset:2048 lds
    buffer_load_dwordx4 v127, s[52:55], s62 offen offset:3072 lds
    s_add_u32 s62, s62, 229376
    s_add_u32 m0, s64, 65536
    s_nop 0
    buffer_load_dwordx4 v8, s[48:51], s61 offen offset:0 lds
    buffer_load_dwordx4 v9, s[48:51], s61 offen offset:1024 lds
    s_add_u32 s61, s61, 128
    s_waitcnt vmcnt(10)
    s_barrier
    s_add_u32 m0, s63, 0
    s_nop 0
    buffer_load_dwordx4 v4, s[44:47], s60 offen offset:0 lds
    buffer_load_dwordx4 v5, s[44:47], s60 offen offset:1024 lds
    buffer_load_dwordx4 v6, s[44:47], s60 offen offset:2048 lds
    buffer_load_dwordx4 v7, s[44:47], s60 offen offset:3072 lds
    s_add_u32 s60, s60, 128
    s_add_u32 m0, s63, 73728
    s_nop 0
    buffer_load_dwordx4 v124, s[52:55], s62 offen offset:0 lds
    buffer_load_dwordx4 v125, s[52:55], s62 offen offset:1024 lds
    buffer_load_dwordx4 v126, s[52:55], s62 offen offset:2048 lds
    buffer_load_dwordx4 v127, s[52:55], s62 offen offset:3072 lds
    s_add_u32 s62, s62, 229376
    s_add_u32 m0, s64, 49152
    s_nop 0
    buffer_load_dwordx4 v8, s[48:51], s61 offen offset:0 lds
    buffer_load_dwordx4 v9, s[48:51], s61 offen offset:1024 lds
    s_add_u32 s61, s61, 128
    s_waitcnt vmcnt(10)
    s_barrier
    s_add_u32 m0, s63, 16384
    s_nop 0
    buffer_load_dwordx4 v4, s[44:47], s60 offen offset:0 lds
    buffer_load_dwordx4 v5, s[44:47], s60 offen offset:1024 lds
    buffer_load_dwordx4 v6, s[44:47], s60 offen offset:2048 lds
    buffer_load_dwordx4 v7, s[44:47], s60 offen offset:3072 lds
    s_add_u32 s60, s60, 128
    s_add_u32 m0, s63, 90112
    s_nop 0
    buffer_load_dwordx4 v124, s[52:55], s62 offen offset:0 lds
    buffer_load_dwordx4 v125, s[52:55], s62 offen offset:1024 lds
    buffer_load_dwordx4 v126, s[52:55], s62 offen offset:2048 lds
    buffer_load_dwordx4 v127, s[52:55], s62 offen offset:3072 lds
    s_add_u32 s62, s62, 229376
    s_add_u32 m0, s64, 57344
    s_nop 0
    buffer_load_dwordx4 v8, s[48:51], s61 offen offset:0 lds
    buffer_load_dwordx4 v9, s[48:51], s61 offen offset:1024 lds
    s_add_u32 s61, s61, 128
    v_lshlrev_b32 v21, 7, v0
    v_mov_b32 v23, 0x7ff00000
    s_cmp_eq_u32 s37, 2
    s_cbranch_scc1 L_t1_2
    s_cmp_eq_u32 s37, 3
    s_cbranch_scc1 L_t1_3
    buffer_load_dword v221, v23, s[44:47], 0 offen
    buffer_load_dword v221, v23, s[44:47], 0 offen
    s_branch L_t1_4
L_t1_2:
    s_mov_b32 s56, s24
    s_and_b32 s57, s25, 0xffff
    s_mov_b32 s58, 1835008
    s_mov_b32 s59, 0x20000
    v_cmp_gt_u32 vcc, 56, v0
    s_mul_i32 s38, s2, 7168
    s_nop 0
    v_cndmask_b32 v20, v23, v21, vcc
    buffer_load_dword v221, v20, s[56:59], s38 offen
    buffer_load_dword v221, v23, s[56:59], s38 offen
    s_branch L_t1_4
L_t1_3:
    v_cmp_gt_u32 vcc, 16, v0
    s_lshl_b32 s38, s2, 11
    s_nop 0
    v_cndmask_b32 v20, v23, v21, vcc
    s_mov_b32 s56, s14
    s_and_b32 s57, s15, 0xffff
    s_mov_b32 s58, 524288
    s_mov_b32 s59, 0x20000
    buffer_load_dword v221, v20, s[56:59], s38 offen
    s_mov_b32 s56, s16
    s_and_b32 s57, s17, 0xffff
    s_mov_b32 s58, 524288
    s_mov_b32 s59, 0x20000
    buffer_load_dword v221, v20, s[56:59], s38 offen
L_t1_4:
    s_waitcnt vmcnt(12)
    s_barrier
    s_add_u32 m0, s63, 32768
    s_nop 0
    buffer_load_dwordx4 v4, s[44:47], s60 offen offset:0 lds
    buffer_load_dwordx4 v5, s[44:47], s60 offen offset:1024 lds
    buffer_load_dwordx4 v6, s[44:47], s60 offen offset:2048 lds
    buffer_load_dwordx4 v7, s[44:47], s60 offen offset:3072 lds
    s_add_u32 s60, s60, 128
    s_add_u32 m0, s63, 106496
    s_nop 0
    buffer_load_dwordx4 v124, s[52:55], s62 offen offset:0 lds
    buffer_load_dwordx4 v125, s[52:55], s62 offen offset:1024 lds
    buffer_load_dwordx4 v126, s[52:55], s62 offen offset:2048 lds
    buffer_load_dwordx4 v127, s[52:55], s62 offen offset:3072 lds
    s_add_u32 s62, s62, 229376
    s_add_u32 m0, s64, 65536
    s_nop 0
    buffer_load_dwordx4 v8, s[48:51], s61 offen offset:0 lds
    buffer_load_dwordx4 v9, s[48:51], s61 offen offset:1024 lds
    s_add_u32 s61, s61, 128
    s_waitcnt vmcnt(12)
    s_barrier
    s_add_u32 m0, s63, 0
    s_nop 0
    buffer_load_dwordx4 v4, s[44:47], s60 offen offset:0 lds
    buffer_load_dwordx4 v5, s[44:47], s60 offen offset:1024 lds
    buffer_load_dwordx4 v6, s[44:47], s60 offen offset:2048 lds
    buffer_load_dwordx4 v7, s[44:47], s60 offen offset:3072 lds
    s_add_u32 s60, s60, 128
    s_add_u32 m0, s63, 73728
    s_nop 0
    buffer_load_dwordx4 v124, s[52:55], s62 offen offset:0 lds
    buffer_load_dwordx4 v125, s[52:55], s62 offen offset:1024 lds
    buffer_load_dwordx4 v126, s[52:55], s62 offen offset:2048 lds
    buffer_load_dwordx4 v127, s[52:55], s62 offen offset:3072 lds
    s_add_u32 s62, s62, 229376
    s_add_u32 m0, s64, 49152
    s_nop 0
    buffer_load_dwordx4 v8, s[48:51], s61 offen offset:0 lds
    buffer_load_dwordx4 v9, s[48:51], s61 offen offset:1024 lds
    s_add_u32 s61, s61, 128
    s_waitcnt vmcnt(10)
    s_barrier
    s_add_u32 m0, s63, 16384
    s_nop 0
    buffer_load_dwordx4 v4, s[44:47], s60 offen offset:0 lds
    buffer_load_dwordx4 v5, s[44:47], s60 offen offset:1024 lds
    buffer_load_dwordx4 v6, s[44:47], s60 offen offset:2048 lds
    buffer_load_dwordx4 v7, s[44:47], s60 offen offset:3072 lds
    s_add_u32 s60, s60, 128
    s_add_u32 m0, s63, 90112
    s_nop 0
    buffer_load_dwordx4 v124, s[52:55], s62 offen offset:0 lds
    buffer_load_dwordx4 v125, s[52:55], s62 offen offset:1024 lds
    buffer_load_dwordx4 v126, s[52:55], s62 offen offset:2048 lds
    buffer_load_dwordx4 v127, s[52:55], s62 offen offset:3072 lds
    s_add_u32 s62, s62, 229376
    s_add_u32 m0, s64, 57344
    s_nop 0
    buffer_load_dwordx4 v8, s[48:51], s61 offen offset:0 lds
    buffer_load_dwordx4 v9, s[48:51], s61 offen offset:1024 lds
    s_add_u32 s61, s61, 128
    v_mov_b32 v26, 0
    buffer_load_dword v27, v26, s[96:99], 0 offen sc1
    v_and_b32 v2, 31, v0
    s_lshl_b32 s38, s33, 5
    v_add_u32 v2, s38, v2
    v_lshlrev_b32 v2, 1, v2
    s_mov_b32 s56, s6
    s_and_b32 s57, s7, 0xffff
    s_mov_b32 s58, 1024
    s_mov_b32 s59, 0x20000
    buffer_load_ushort v40, v2, s[56:59], 0 offen
    s_mov_b32 s56, s8
    s_and_b32 s57, s9, 0xffff
    s_mov_b32 s58, 1024
    s_mov_b32 s59, 0x20000
    buffer_load_ushort v41, v2, s[56:59], 0 offen
    s_mov_b32 s56, s18
    s_and_b32 s57, s19, 0xffff
    s_mov_b32 s58, 1024
    s_mov_b32 s59, 0x20000
    buffer_load_ushort v42, v2, s[56:59], 0 offen
    s_waitcnt vmcnt(14)
    s_barrier
    s_waitcnt vmcnt(4)
    s_barrier
    s_waitcnt vmcnt(3)
    v_readfirstlane_b32 s69, v27
    s_cmp_lg_u32 s69, 0
    s_cbranch_scc1 L_npoll_ok
    s_mov_b32 s65, 262144
L_npoll:
    buffer_load_dword v27, v26, s[96:99], 0 offen sc1
    s_waitcnt vmcnt(0)
    v_readfirstlane_b32 s69, v27
    s_cmp_lg_u32 s69, 0
    s_cbranch_scc1 L_npoll_ok
    s_sleep 4
    s_sub_u32 s65, s65, 1
    s_cmp_lg_u32 s65, 0
    s_cbranch_scc1 L_npoll
L_npoll_ok:
    v_mov_b32 v20, s69
    v_mov_b32 v21, 135168
    ds_write_b32 v21, v20
    s_waitcnt lgkmcnt(0)
    s_barrier
    s_cmp_eq_u32 s37, 2
    s_cbranch_scc1 L_bloader
    s_cmp_eq_u32 s37, 3
    s_cbranch_scc1 L_helper
    s_cmp_eq_u32 s37, 0
    s_cbranch_scc0 L_nogate
    s_mov_b32 s56, s26
    s_and_b32 s57, s27, 0xffff
    s_mov_b32 s58, 1024
    s_mov_b32 s59, 0x20000
    v_lshlrev_b32 v3, 4, v0
    buffer_load_dwordx4 v[60:63], v3, s[56:59], 0 offen
    s_lshl_b32 s38, s32, 7
    s_lshl_b32 s39, s33, 3
    s_add_u32 s38, s38, s39
    s_lshl_b32 s38, s38, 10
    buffer_load_dwordx4 v[64:67], v3, s[44:47], s38 offen
    s_add_u32 s38, s38, 1024
    buffer_load_dwordx4 v[68:71], v3, s[44:47], s38 offen
    s_add_u32 s38, s38, 1024
    buffer_load_dwordx4 v[72:75], v3, s[44:47], s38 offen
    s_add_u32 s38, s38, 1024
    buffer_load_dwordx4 v[76:79], v3, s[44:47], s38 offen
    s_add_u32 s38, s38, 1024
    buffer_load_dwordx4 v[80:83], v3, s[44:47], s38 offen
    s_add_u32 s38, s38, 1024
    buffer_load_dwordx4 v[84:87], v3, s[44:47], s38 offen
    s_add_u32 s38, s38, 1024
    buffer_load_dwordx4 v[88:91], v3, s[44:47], s38 offen
    s_add_u32 s38, s38, 1024
    buffer_load_dwordx4 v[92:95], v3, s[44:47], s38 offen
    s_add_u32 s38, s38, 1024
    s_waitcnt vmcnt(0)
    v_mov_b32 v96, 0
    v_mov_b32 v97, 0
    v_mov_b32 v98, 0
    v_mov_b32 v99, 0
    v_mov_b32 v100, 0
    v_mov_b32 v101, 0
    v_mov_b32 v102, 0
    v_mov_b32 v103, 0
    v_dot2c_f32_bf16 v96, v64, v60
    v_dot2c_f32_bf16 v96, v65, v61
    v_dot2c_f32_bf16 v96, v66, v62
    v_dot2c_f32_bf16 v96, v67, v63
    v_dot2c_f32_bf16 v97, v68, v60
    v_dot2c_f32_bf16 v97, v69, v61
    v_dot2c_f32_bf16 v97, v70, v62
    v_dot2c_f32_bf16 v97, v71, v63
    v_dot2c_f32_bf16 v98, v72, v60
    v_dot2c_f32_bf16 v98, v73, v61
    v_dot2c_f32_bf16 v98, v74, v62
    v_dot2c_f32_bf16 v98, v75, v63
    v_dot2c_f32_bf16 v99, v76, v60
    v_dot2c_f32_bf16 v99, v77, v61
    v_dot2c_f32_bf16 v99, v78, v62
    v_dot2c_f32_bf16 v99, v79, v63
    v_dot2c_f32_bf16 v100, v80, v60
    v_dot2c_f32_bf16 v100, v81, v61
    v_dot2c_f32_bf16 v100, v82, v62
    v_dot2c_f32_bf16 v100, v83, v63
    v_dot2c_f32_bf16 v101, v84, v60
    v_dot2c_f32_bf16 v101, v85, v61
    v_dot2c_f32_bf16 v101, v86, v62
    v_dot2c_f32_bf16 v101, v87, v63
    v_dot2c_f32_bf16 v102, v88, v60
    v_dot2c_f32_bf16 v102, v89, v61
    v_dot2c_f32_bf16 v102, v90, v62
    v_dot2c_f32_bf16 v102, v91, v63
    v_dot2c_f32_bf16 v103, v92, v60
    v_dot2c_f32_bf16 v103, v93, v61
    v_dot2c_f32_bf16 v103, v94, v62
    v_dot2c_f32_bf16 v103, v95, v63
    s_nop 1
    v_add_f32_dpp v96, v96, v96 quad_perm:[1,0,3,2] row_mask:0xf bank_mask:0xf
    v_add_f32_dpp v97, v97, v97 quad_perm:[1,0,3,2] row_mask:0xf bank_mask:0xf
    v_add_f32_dpp v98, v98, v98 quad_perm:[1,0,3,2] row_mask:0xf bank_mask:0xf
    v_add_f32_dpp v99, v99, v99 quad_perm:[1,0,3,2] row_mask:0xf bank_mask:0xf
    v_add_f32_dpp v100, v100, v100 quad_perm:[1,0,3,2] row_mask:0xf bank_mask:0xf
    v_add_f32_dpp v101, v101, v101 quad_perm:[1,0,3,2] row_mask:0xf bank_mask:0xf
    v_add_f32_dpp v102, v102, v102 quad_perm:[1,0,3,2] row_mask:0xf bank_mask:0xf
    v_add_f32_dpp v103, v103, v103 quad_perm:[1,0,3,2] row_mask:0xf bank_mask:0xf
    s_nop 1
    v_add_f32_dpp v96, v96, v96 quad_perm:[2,3,0,1] row_mask:0xf bank_mask:0xf
    v_add_f32_dpp v97, v97, v97 quad_perm:[2,3,0,1] row_mask:0xf bank_mask:0xf
    v_add_f32_dpp v98, v98, v98 quad_perm:[2,3,0,1] row_mask:0xf bank_mask:0xf
    v_add_f32_dpp v99, v99, v99 quad_perm:[2,3,0,1] row_mask:0xf bank_mask:0xf
    v_add_f32_dpp v100, v100, v100 quad_perm:[2,3,0,1] row_mask:0xf bank_mask:0xf
    v_add_f32_dpp v101, v101, v101 quad_perm:[2,3,0,1] row_mask:0xf bank_mask:0xf
    v_add_f32_dpp v102, v102, v102 quad_perm:[2,3,0,1] row_mask:0xf bank_mask:0xf
    v_add_f32_dpp v103, v103, v103 quad_perm:[2,3,0,1] row_mask:0xf bank_mask:0xf
    s_nop 1
    v_add_f32_dpp v96, v96, v96 row_half_mirror row_mask:0xf bank_mask:0xf
    v_add_f32_dpp v97, v97, v97 row_half_mirror row_mask:0xf bank_mask:0xf
    v_add_f32_dpp v98, v98, v98 row_half_mirror row_mask:0xf bank_mask:0xf
    v_add_f32_dpp v99, v99, v99 row_half_mirror row_mask:0xf bank_mask:0xf
    v_add_f32_dpp v100, v100, v100 row_half_mirror row_mask:0xf bank_mask:0xf
    v_add_f32_dpp v101, v101, v101 row_half_mirror row_mask:0xf bank_mask:0xf
    v_add_f32_dpp v102, v102, v102 row_half_mirror row_mask:0xf bank_mask:0xf
    v_add_f32_dpp v103, v103, v103 row_half_mirror row_mask:0xf bank_mask:0xf
    s_nop 1
    v_add_f32_dpp v96, v96, v96 row_mirror row_mask:0xf bank_mask:0xf
    v_add_f32_dpp v97, v97, v97 row_mirror row_mask:0xf bank_mask:0xf
    v_add_f32_dpp v98, v98, v98 row_mirror row_mask:0xf bank_mask:0xf
    v_add_f32_dpp v99, v99, v99 row_mirror row_mask:0xf bank_mask:0xf
    v_add_f32_dpp v100, v100, v100 row_mirror row_mask:0xf bank_mask:0xf
    v_add_f32_dpp v101, v101, v101 row_mirror row_mask:0xf bank_mask:0xf
    v_add_f32_dpp v102, v102, v102 row_mirror row_mask:0xf bank_mask:0xf
    v_add_f32_dpp v103, v103, v103 row_mirror row_mask:0xf bank_mask:0xf
    v_mov_b32 v104, v96
    v_mov_b32 v105, v97
    v_mov_b32 v106, v98
    v_mov_b32 v107, v99
    v_mov_b32 v108, v100
    v_mov_b32 v109, v101
    v_mov_b32 v110, v102
    v_mov_b32 v111, v103
    s_nop 1
    v_permlane16_swap_b32 v96, v104
    v_permlane16_swap_b32 v97, v105
    v_permlane16_swap_b32 v98, v106
    v_permlane16_swap_b32 v99, v107
    v_permlane16_swap_b32 v100, v108
    v_permlane16_swap_b32 v101, v109
    v_permlane16_swap_b32 v102, v110
    v_permlane16_swap_b32 v103, v111
    s_nop 1
    v_add_f32 v96, v96, v104
    v_add_f32 v97, v97, v105
    v_add_f32 v98, v98, v106
    v_add_f32 v99, v99, v107
    v_add_f32 v100, v100, v108
    v_add_f32 v101, v101, v109
    v_add_f32 v102, v102, v110
    v_add_f32 v103, v103, v111
    v_mov_b32 v104, v96
    v_mov_b32 v105, v97
    v_mov_b32 v106, v98
    v_mov_b32 v107, v99
    v_mov_b32 v108, v100
    v_mov_b32 v109, v101
    v_mov_b32 v110, v102
    v_mov_b32 v111, v103
    s_nop 1
    v_permlane32_swap_b32 v96, v104
    v_permlane32_swap_b32 v97, v105
    v_permlane32_swap_b32 v98, v106
    v_permlane32_swap_b32 v99, v107
    v_permlane32_swap_b32 v100, v108
    v_permlane32_swap_b32 v101, v109
    v_permlane32_swap_b32 v102, v110
    v_permlane32_swap_b32 v103, v111
    s_nop 1
    v_add_f32 v96, v96, v104
    v_add_f32 v97, v97, v105
    v_add_f32 v98, v98, v106
    v_add_f32 v99, v99, v107
    v_add_f32 v100, v100, v108
    v_add_f32 v101, v101, v109
    v_add_f32 v102, v102, v110
    v_add_f32 v103, v103, v111
    v_mov_b32 v20, v96
    v_cmp_eq_u32 vcc, 1, v0
    s_nop 1
    v_cndmask_b32 v20, v20, v97, vcc
    v_cmp_eq_u32 vcc, 2, v0
    s_nop 1
    v_cndmask_b32 v20, v20, v98, vcc
    v_cmp_eq_u32 vcc, 3, v0
    s_nop 1
    v_cndmask_b32 v20, v20, v99, vcc
    v_cmp_eq_u32 vcc, 4, v0
    s_nop 1
    v_cndmask_b32 v20, v20, v100, vcc
    v_cmp_eq_u32 vcc, 5, v0
    s_nop 1
    v_cndmask_b32 v20, v20, v101, vcc
    v_cmp_eq_u32 vcc, 6, v0
    s_nop 1
    v_cndmask_b32 v20, v20, v102, vcc
    v_cmp_eq_u32 vcc, 7, v0
    s_nop 1
    v_cndmask_b32 v20, v20, v103, vcc
    v_mul_f32 v20, 3216550459, v20
    v_exp_f32 v20, v20
    s_nop 0
    v_add_f32 v20, 1.0, v20
    v_rcp_f32 v20, v20
    s_lshl_b32 s38, s32, 7
    s_lshl_b32 s39, s33, 3
    s_add_u32 s38, s38, s39
    s_lshl_b32 s38, s38, 2
    s_add_u32 s38, s38, 14680064
    v_lshlrev_b32 v21, 2, v0
    v_cmp_gt_u32 vcc, 8, v0
    s_and_saveexec_b64 s[66:67], vcc
    buffer_store_dword v20, v21, s[40:43], s38 offen sc1
    s_mov_b64 exec, s[66:67]
    s_waitcnt vmcnt(0)
L_nogate:
    s_and_b32 s38, s33, 1
    s_lshl_b32 s38, s38, 1
    s_add_u32 s36, s38, s37
    s_lshl_b32 s39, s32, 2
    s_add_u32 s39, s39, s36
    s_mul_i32 s62, s39, 180224
    s_lshl_b32 s39, s39, 6
    s_add_u32 s38, s39, 14942208
    s_add_u32 s56, s30, s38
    s_addc_u32 s57, s31, 0
    s_add_u32 s38, s39, 15073280
    s_add_u32 s58, s30, s38
    s_addc_u32 s59, s31, 0
    s_and_b32 s20, s33, 8
    s_lshr_b32 s38, s20, 3
    s_mul_i32 s38, s38, 14
    s_sub_u32 s35, 28, s38
    s_lshl_b32 s38, s38, 12
    s_add_u32 s60, s62, s38
    s_lshl_b32 s61, s37, 12
    v_lshlrev_b32 v1, 4, v0
    s_getpc_b64 s[66:67]
L_pcA:
    s_add_u32 s66, s66, L_fapoll-L_pcA
    s_addc_u32 s67, s67, 0
    s_lshl_b32 s38, s36, 2
    s_add_u32 s38, s38, 135184
    v_mov_b32 v22, s38
    s_mov_b32 s65, 262144
L_dspin:
    ds_read_b32 v23, v22
    s_waitcnt lgkmcnt(0)
    v_readfirstlane_b32 s38, v23
    s_cmp_lg_u32 s38, 0
    s_cbranch_scc1 L_dspin_ok
    s_sleep 1
    s_sub_u32 s65, s65, 1
    s_cmp_lg_u32 s65, 0
    s_cbranch_scc1 L_dspin
L_dspin_ok:
    s_mov_b32 s63, 63
    s_mov_b32 s64, 0
    s_load_dwordx16 s[4:19], s[56:57], 0 glc
    s_cmp_gt_u32 s64, s63
    s_cbranch_scc1 L_chk_5
    s_swappc_b64 s[90:91], s[66:67]
L_chk_5:
    s_mov_b32 m0, s61
    s_add_u32 s61, s61, 8192
    s_cmp_ge_u32 s61, 40960
    s_cselect_b32 s38, 40960, 0
    s_sub_u32 s61, s61, s38
    buffer_load_dwordx4 v1, s[40:43], s60 offen offset:0 sc1 lds
    buffer_load_dwordx4 v1, s[40:43], s60 offen offset:1024 sc1 lds
    buffer_load_dwordx4 v1, s[40:43], s60 offen offset:2048 sc1 lds
    buffer_load_dwordx4 v1, s[40:43], s60 offen offset:3072 sc1 lds
    s_add_u32 s60, s60, 4096
    s_sub_u32 s35, s35, 1
    s_cmp_eq_u32 s35, 0
    s_cselect_b32 s38, 114688, 0
    s_sub_u32 s60, s60, s38
    s_add_u32 s63, s63, 64
    s_cmp_gt_u32 s64, s63
    s_cbranch_scc1 L_chk_6
    s_swappc_b64 s[90:91], s[66:67]
L_chk_6:
    s_mov_b32 m0, s61
    s_add_u32 s61, s61, 8192
    s_cmp_ge_u32 s61, 40960
    s_cselect_b32 s38, 40960, 0
    s_sub_u32 s61, s61, s38
    buffer_load_dwordx4 v1, s[40:43], s60 offen offset:0 sc1 lds
    buffer_load_dwordx4 v1, s[40:43], s60 offen offset:1024 sc1 lds
    buffer_load_dwordx4 v1, s[40:43], s60 offen offset:2048 sc1 lds
    buffer_load_dwordx4 v1, s[40:43], s60 offen offset:3072 sc1 lds
    s_add_u32 s60, s60, 4096
    s_sub_u32 s35, s35, 1
    s_cmp_eq_u32 s35, 0
    s_cselect_b32 s38, 114688, 0
    s_sub_u32 s60, s60, s38
    s_add_u32 s63, s63, 64
    s_cmp_gt_u32 s64, s63
    s_cbranch_scc1 L_chk_7
    s_swappc_b64 s[90:91], s[66:67]
L_chk_7:
    s_mov_b32 m0, s61
    s_add_u32 s61, s61, 8192
    s_cmp_ge_u32 s61, 40960
    s_cselect_b32 s38, 40960, 0
    s_sub_u32 s61, s61, s38
    buffer_load_dwordx4 v1, s[40:43], s60 offen offset:0 sc1 lds
    buffer_load_dwordx4 v1, s[40:43], s60 offen offset:1024 sc1 lds
    buffer_load_dwordx4 v1, s[40:43], s60 offen offset:2048 sc1 lds
    buffer_load_dwordx4 v1, s[40:43], s60 offen offset:3072 sc1 lds
    s_add_u32 s60, s60, 4096
    s_sub_u32 s35, s35, 1
    s_cmp_eq_u32 s35, 0
    s_cselect_b32 s38, 114688, 0
    s_sub_u32 s60, s60, s38
    s_add_u32 s63, s63, 64
    s_waitcnt vmcnt(8)
    s_barrier
    s_cmp_gt_u32 s64, s63
    s_cbranch_scc1 L_chk_8
    s_swappc_b64 s[90:91], s[66:67]
L_chk_8:
    s_mov_b32 m0, s61
    s_add_u32 s61, s61, 8192
    s_cmp_ge_u32 s61, 40960
    s_cselect_b32 s38, 40960, 0
    s_sub_u32 s61, s61, s38
    buffer_load_dwordx4 v1, s[40:43], s60 offen offset:0 sc1 lds
    buffer_load_dwordx4 v1, s[40:43], s60 offen offset:1024 sc1 lds
    buffer_load_dwordx4 v1, s[40:43], s60 offen offset:2048 sc1 lds
    buffer_load_dwordx4 v1, s[40:43], s60 offen offset:3072 sc1 lds
    s_add_u32 s60, s60, 4096
    s_sub_u32 s35, s35, 1
    s_cmp_eq_u32 s35, 0
    s_cselect_b32 s38, 114688, 0
    s_sub_u32 s60, s60, s38
    s_add_u32 s63, s63, 64
    s_cmp_gt_u32 s64, s63
    s_cbranch_scc1 L_chk_9
    s_swappc_b64 s[90:91], s[66:67]
L_chk_9:
    s_mov_b32 m0, s61
    s_add_u32 s61, s61, 8192
    s_cmp_ge_u32 s61, 40960
    s_cselect_b32 s38, 40960, 0
    s_sub_u32 s61, s61, s38
    buffer_load_dwordx4 v1, s[40:43], s60 offen offset:0 sc1 lds
    buffer_load_dwordx4 v1, s[40:43], s60 offen offset:1024 sc1 lds
    buffer_load_dwordx4 v1, s[40:43], s60 offen offset:2048 sc1 lds
    buffer_load_dwordx4 v1, s[40:43], s60 offen offset:3072 sc1 lds
    s_add_u32 s60, s60, 4096
    s_sub_u32 s35, s35, 1
    s_cmp_eq_u32 s35, 0
    s_cselect_b32 s38, 114688, 0
    s_sub_u32 s60, s60, s38
    s_add_u32 s63, s63, 64
    s_mov_b32 s92, 21
L_a1:
    s_waitcnt vmcnt(12)
    s_barrier
    s_cmp_gt_u32 s64, s63
    s_cbranch_scc1 L_chk_10
    s_swappc_b64 s[90:91], s[66:67]
L_chk_10:
    s_mov_b32 m0, s61
    s_add_u32 s61, s61, 8192
    s_cmp_ge_u32 s61, 40960
    s_cselect_b32 s38, 40960, 0
    s_sub_u32 s61, s61, s38
    buffer_load_dwordx4 v1, s[40:43], s60 offen offset:0 sc1 lds
    buffer_load_dwordx4 v1, s[40:43], s60 offen offset:1024 sc1 lds
    buffer_load_dwordx4 v1, s[40:43], s60 offen offset:2048 sc1 lds
    buffer_load_dwordx4 v1, s[40:43], s60 offen offset:3072 sc1 lds
    s_add_u32 s60, s60, 4096
    s_sub_u32 s35, s35, 1
    s_cmp_eq_u32 s35, 0
    s_cselect_b32 s38, 114688, 0
    s_sub_u32 s60, s60, s38
    s_add_u32 s63, s63, 64
    s_sub_u32 s92, s92, 1
    s_cmp_lg_u32 s92, 0
    s_cbranch_scc1 L_a1
    s_waitcnt vmcnt(12)
    s_barrier
    s_mov_b32 s63, 1791
    s_cmp_gt_u32 s64, s63
    s_cbranch_scc1 L_chk_11
    s_swappc_b64 s[90:91], s[66:67]
L_chk_11:
    s_mov_b32 m0, s61
    s_add_u32 s61, s61, 8192
    s_cmp_ge_u32 s61, 40960
    s_cselect_b32 s38, 40960, 0
    s_sub_u32 s61, s61, s38
    buffer_load_dwordx4 v1, s[40:43], s60 offen offset:0 sc1 lds
    buffer_load_dwordx4 v1, s[40:43], s60 offen offset:1024 sc1 lds
    buffer_load_dwordx4 v1, s[40:43], s60 offen offset:2048 sc1 lds
    buffer_load_dwordx4 v1, s[40:43], s60 offen offset:3072 sc1 lds
    s_add_u32 s60, s60, 4096
    s_sub_u32 s35, s35, 1
    s_cmp_eq_u32 s35, 0
    s_cselect_b32 s38, 114688, 0
    s_sub_u32 s60, s60, s38
    s_add_u32 s63, s63, 64
    s_load_dwordx16 s[4:19], s[58:59], 0 glc
    s_waitcnt vmcnt(12)
    s_barrier
    s_cmp_gt_u32 s64, s63
    s_cbranch_scc1 L_chk_12
    s_swappc_b64 s[90:91], s[66:67]
L_chk_12:
    s_mov_b32 m0, s61
    s_add_u32 s61, s61, 8192
    s_cmp_ge_u32 s61, 40960
    s_cselect_b32 s38, 40960, 0
    s_sub_u32 s61, s61, s38
    buffer_load_dwordx4 v1, s[40:43], s60 offen offset:0 sc1 lds
    buffer_load_dwordx4 v1, s[40:43], s60 offen offset:1024 sc1 lds
    buffer_load_dwordx4 v1, s[40:43], s60 offen offset:2048 sc1 lds
    buffer_load_dwordx4 v1, s[40:43], s60 offen offset:3072 sc1 lds
    s_add_u32 s60, s60, 4096
    s_sub_u32 s35, s35, 1
    s_cmp_eq_u32 s35, 0
    s_cselect_b32 s38, 114688, 0
    s_sub_u32 s60, s60, s38
    s_add_u32 s63, s63, 64
    s_waitcnt vmcnt(12)
    s_barrier
    s_waitcnt lgkmcnt(0)
    s_mov_b32 s38, 0
    s_xor_b32 s39, s4, s69
    s_or_b32 s38, s38, s39
    s_xor_b32 s39, s5, s69
    s_or_b32 s38, s38, s39
    s_xor_b32 s39, s6, s69
    s_or_b32 s38, s38, s39
    s_xor_b32 s39, s7, s69
    s_or_b32 s38, s38, s39
    s_xor_b32 s39, s8, s69
    s_or_b32 s38, s38, s39
    s_xor_b32 s39, s9, s69
    s_or_b32 s38, s38, s39
    s_xor_b32 s39, s10, s69
    s_or_b32 s38, s38, s39
    s_xor_b32 s39, s11, s69
    s_or_b32 s38, s38, s39
    s_xor_b32 s39, s12, s69
    s_or_b32 s38, s38, s39
    s_xor_b32 s39, s13, s69
    s_or_b32 s38, s38, s39
    s_xor_b32 s39, s14, s69
    s_or_b32 s38, s38, s39
    s_xor_b32 s39, s15, s69
    s_or_b32 s38, s38, s39
    s_xor_b32 s39, s16, s69
    s_or_b32 s38, s38, s39
    s_xor_b32 s39, s17, s69
    s_or_b32 s38, s38, s39
    s_xor_b32 s39, s18, s69
    s_or_b32 s38, s38, s39
    s_xor_b32 s39, s19, s69
    s_or_b32 s38, s38, s39
    s_cmp_eq_u32 s38, 0
    s_cbranch_scc1 L_fhok
    s_mov_b32 s65, 262144
L_pollH:
    s_load_dwordx16 s[4:19], s[58:59], 0 glc
    s_waitcnt lgkmcnt(0)
    s_mov_b32 s38, 0
    s_xor_b32 s39, s4, s69
    s_or_b32 s38, s38, s39
    s_xor_b32 s39, s5, s69
    s_or_b32 s38, s38, s39
    s_xor_b32 s39, s6, s69
    s_or_b32 s38, s38, s39
    s_xor_b32 s39, s7, s69
    s_or_b32 s38, s38, s39
    s_xor_b32 s39, s8, s69
    s_or_b32 s38, s38, s39
    s_xor_b32 s39, s9, s69
    s_or_b32 s38, s38, s39
    s_xor_b32 s39, s10, s69
    s_or_b32 s38, s38, s39
    s_xor_b32 s39, s11, s69
    s_or_b32 s38, s38, s39
    s_xor_b32 s39, s12, s69
    s_or_b32 s38, s38, s39
    s_xor_b32 s39, s13, s69
    s_or_b32 s38, s38, s39
    s_xor_b32 s39, s14, s69
    s_or_b32 s38, s38, s39
    s_xor_b32 s39, s15, s69
    s_or_b32 s38, s38, s39
    s_xor_b32 s39, s16, s69
    s_or_b32 s38, s38, s39
    s_xor_b32 s39, s17, s69
    s_or_b32 s38, s38, s39
    s_xor_b32 s39, s18, s69
    s_or_b32 s38, s38, s39
    s_xor_b32 s39, s19, s69
    s_or_b32 s38, s38, s39
    s_cmp_eq_u32 s38, 0
    s_cbranch_scc1 L_fhok
    s_sub_u32 s65, s65, 1
    s_cmp_lg_u32 s65, 0
    s_cbranch_scc1 L_pollH
L_fhok:
    s_add_u32 s60, s62, 114688
    s_mov_b32 m0, s61
    s_add_u32 s61, s61, 8192
    s_cmp_ge_u32 s61, 40960
    s_cselect_b32 s38, 40960, 0
    s_sub_u32 s61, s61, s38
    buffer_load_dwordx4 v1, s[40:43], s60 offen offset:0 sc1 lds
    buffer_load_dwordx4 v1, s[40:43], s60 offen offset:1024 sc1 lds
    buffer_load_dwordx4 v1, s[40:43], s60 offen offset:2048 sc1 lds
    buffer_load_dwordx4 v1, s[40:43], s60 offen offset:3072 sc1 lds
    s_add_u32 s60, s60, 4096
    s_mov_b32 s92, 15
L_a2:
    s_waitcnt vmcnt(12)
    s_barrier
    s_mov_b32 m0, s61
    s_add_u32 s61, s61, 8192
    s_cmp_ge_u32 s61, 40960
    s_cselect_b32 s38, 40960, 0
    s_sub_u32 s61, s61, s38
    buffer_load_dwordx4 v1, s[40:43], s60 offen offset:0 sc1 lds
    buffer_load_dwordx4 v1, s[40:43], s60 offen offset:1024 sc1 lds
    buffer_load_dwordx4 v1, s[40:43], s60 offen offset:2048 sc1 lds
    buffer_load_dwordx4 v1, s[40:43], s60 offen offset:3072 sc1 lds
    s_add_u32 s60, s60, 4096
    s_sub_u32 s92, s92, 1
    s_cmp_lg_u32 s92, 0
    s_cbranch_scc1 L_a2
    s_waitcnt vmcnt(12)
    s_barrier
    s_waitcnt vmcnt(8)
    s_barrier
    s_waitcnt vmcnt(4)
    s_barrier
    s_waitcnt vmcnt(0)
    s_barrier
    s_endpgm
L_fapoll:
    s_mov_b32 s65, 262144
L_fap1:
    s_waitcnt lgkmcnt(0)
    s_mov_b32 s38, 0
    s_cmp_eq_u32 s19, s69
    s_addc_u32 s38, s38, s38
    s_cmp_eq_u32 s18, s69
    s_addc_u32 s38, s38, s38
    s_cmp_eq_u32 s17, s69
    s_addc_u32 s38, s38, s38
    s_cmp_eq_u32 s16, s69
    s_addc_u32 s38, s38, s38
    s_cmp_eq_u32 s15, s69
    s_addc_u32 s38, s38, s38
    s_cmp_eq_u32 s14, s69
    s_addc_u32 s38, s38, s38
    s_cmp_eq_u32 s13, s69
    s_addc_u32 s38, s38, s38
    s_cmp_eq_u32 s12, s69
    s_addc_u32 s38, s38, s38
    s_cmp_eq_u32 s11, s69
    s_addc_u32 s38, s38, s38
    s_cmp_eq_u32 s10, s69
    s_addc_u32 s38, s38, s38
    s_cmp_eq_u32 s9, s69
    s_addc_u32 s38, s38, s38
    s_cmp_eq_u32 s8, s69
    s_addc_u32 s38, s38, s38
    s_cmp_eq_u32 s7, s69
    s_addc_u32 s38, s38, s38
    s_cmp_eq_u32 s6, s69
    s_addc_u32 s38, s38, s38
    s_cmp_eq_u32 s5, s69
    s_addc_u32 s38, s38, s38
    s_cmp_eq_u32 s4, s69
    s_addc_u32 s38, s38, s38
    s_lshl_b32 s39, 1, s33
    s_or_b32 s38, s38, s39
    s_lshl_b32 s39, s38, 16
    s_or_b32 s38, s38, s39
    s_lshr_b32 s38, s38, s20
    s_and_b32 s38, s38, 0xffff
    s_ff0_i32_b32 s21, s38
    s_mul_i32 s64, s21, 112
    s_cmp_eq_u32 s21, 16
    s_cselect_b32 s64, 9999, s64
    s_cbranch_scc1 L_fap2
    s_load_dwordx16 s[4:19], s[56:57], 0 glc
    s_cmp_gt_u32 s64, s63
    s_cbranch_scc1 L_fap2
    s_sub_u32 s65, s65, 1
    s_cmp_lg_u32 s65, 0
    s_cbranch_scc1 L_fap1
L_fap2:
    s_setpc_b64 s[90:91]
L_bloader:
    s_mov_b32 s44, s24
    s_and_b32 s45, s25, 0xffff
    s_mov_b32 s46, 1835008
    s_mov_b32 s47, 0x20000
    s_mov_b32 s48, s14
    s_and_b32 s49, s15, 0xffff
    s_mov_b32 s50, 524288
    s_mov_b32 s51, 0x20000
    s_mov_b32 s52, s16
    s_and_b32 s53, s17, 0xffff
    s_mov_b32 s54, 524288
    s_mov_b32 s55, 0x20000
    v_lshrrev_b32 v12, 3, v0
    v_and_b32 v13, 7, v0
    v_lshrrev_b32 v14, 4, v0
    v_and_b32 v15, 1, v14
    v_lshlrev_b32 v15, 2, v15
    v_xor_b32 v15, v13, v15
    v_lshlrev_b32 v15, 4, v15
    v_lshlrev_b32 v16, 10, v12
    v_add_u32 v16, v16, v15
    v_add_u32 v64, 0, v16
    v_add_u32 v65, 7168, v16
    v_add_u32 v66, 14336, v16
    v_add_u32 v67, 21504, v16
    v_add_u32 v68, 32768, v16
    v_add_u32 v69, 39936, v16
    v_add_u32 v70, 47104, v16
    v_add_u32 v71, 54272, v16
    v_add_u32 v15, 0, v14
    v_and_b32 v15, 7, v15
    v_xor_b32 v15, v13, v15
    v_lshlrev_b32 v15, 4, v15
    v_lshlrev_b32 v16, 10, v12
    v_add_u32 v16, v16, v15
    v_add_u32 v72, 0, v16
    v_add_u32 v15, 4, v14
    v_and_b32 v15, 7, v15
    v_xor_b32 v15, v13, v15
    v_lshlrev_b32 v15, 4, v15
    v_lshlrev_b32 v16, 10, v12
    v_add_u32 v16, v16, v15
    v_add_u32 v73, 7168, v16
    v_add_u32 v15, 8, v14
    v_and_b32 v15, 7, v15
    v_xor_b32 v15, v13, v15
    v_lshlrev_b32 v15, 4, v15
    v_lshlrev_b32 v16, 10, v12
    v_add_u32 v16, v16, v15
    v_add_u32 v74, 14336, v16
    v_add_u32 v15, 12, v14
    v_and_b32 v15, 7, v15
    v_xor_b32 v15, v13, v15
    v_lshlrev_b32 v15, 4, v15
    v_lshlrev_b32 v16, 10, v12
    v_add_u32 v16, v16, v15
    v_add_u32 v75, 21504, v16
    v_add_u32 v15, 16, v14
    v_and_b32 v15, 7, v15
    v_xor_b32 v15, v13, v15
    v_lshlrev_b32 v15, 4, v15
    v_lshlrev_b32 v16, 10, v12
    v_add_u32 v16, v16, v15
    v_add_u32 v76, 32768, v16
    v_add_u32 v15, 20, v14
    v_and_b32 v15, 7, v15
    v_xor_b32 v15, v13, v15
    v_lshlrev_b32 v15, 4, v15
    v_lshlrev_b32 v16, 10, v12
    v_add_u32 v16, v16, v15
    v_add_u32 v77, 39936, v16
    v_add_u32 v15, 24, v14
    v_and_b32 v15, 7, v15
    v_xor_b32 v15, v13, v15
    v_lshlrev_b32 v15, 4, v15
    v_lshlrev_b32 v16, 10, v12
    v_add_u32 v16, v16, v15
    v_add_u32 v78, 47104, v16
    v_add_u32 v15, 28, v14
    v_and_b32 v15, 7, v15
    v_xor_b32 v15, v13, v15
    v_lshlrev_b32 v15, 4, v15
    v_lshlrev_b32 v16, 10, v12
    v_add_u32 v16, v16, v15
    v_add_u32 v79, 54272, v16
    s_lshr_b32 s62, s33, 1
    s_lshl_b32 s60, s62, 7
    s_lshr_b32 s38, s33, 3
    s_mul_i32 s38, s38, 14
    s_sub_u32 s35, 28, s38
    s_lshl_b32 s38, s38, 16
    s_add_u32 s60, s60, s38
    s_mov_b32 s61, 40960
    v_mov_b32 v22, 135176
    s_mov_b32 s65, 262144
L_mspinB:
    ds_read_b32 v23, v22
    s_waitcnt lgkmcnt(0)
    v_readfirstlane_b32 s38, v23
    s_cmp_ge_u32 s38, 4
    s_cbranch_scc1 L_mspinB_ok
    s_sleep 1
    s_sub_u32 s65, s65, 1
    s_cmp_lg_u32 s65, 0
    s_cbranch_scc1 L_mspinB
L_mspinB_ok:
    s_mov_b32 s64, 7
L_b0:
    s_mov_b32 m0, s61
    s_add_u32 s39, s61, 4096
    buffer_load_dwordx4 v64, s[44:47], s60 offen offset:0 lds
    buffer_load_dwordx4 v65, s[44:47], s60 offen offset:1024 lds
    buffer_load_dwordx4 v66, s[44:47], s60 offen offset:2048 lds
    buffer_load_dwordx4 v67, s[44:47], s60 offen offset:3072 lds
    s_mov_b32 m0, s39
    s_add_u32 s61, s61, 8192
    s_cmp_ge_u32 s61, 131072
    s_cselect_b32 s38, 90112, 0
    s_sub_u32 s61, s61, s38
    buffer_load_dwordx4 v68, s[44:47], s60 offen offset:0 lds
    buffer_load_dwordx4 v69, s[44:47], s60 offen offset:1024 lds
    buffer_load_dwordx4 v70, s[44:47], s60 offen offset:2048 lds
    buffer_load_dwordx4 v71, s[44:47], s60 offen offset:3072 lds
    s_add_u32 s60, s60, 65536
    s_sub_u32 s35, s35, 1
    s_cmp_eq_u32 s35, 0
    s_cselect_b32 s38, 1835008, 0
    s_sub_u32 s60, s60, s38
    s_sub_u32 s64, s64, 1
    s_cmp_lg_u32 s64, 0
    s_cbranch_scc1 L_b0
    s_mov_b32 s64, 21
L_b1:
    s_waitcnt vmcnt(48)
    s_barrier
    s_mov_b32 m0, s61
    s_add_u32 s39, s61, 4096
    buffer_load_dwordx4 v64, s[44:47], s60 offen offset:0 lds
    buffer_load_dwordx4 v65, s[44:47], s60 offen offset:1024 lds
    buffer_load_dwordx4 v66, s[44:47], s60 offen offset:2048 lds
    buffer_load_dwordx4 v67, s[44:47], s60 offen offset:3072 lds
    s_mov_b32 m0, s39
    s_add_u32 s61, s61, 8192
    s_cmp_ge_u32 s61, 131072
    s_cselect_b32 s38, 90112, 0
    s_sub_u32 s61, s61, s38
    buffer_load_dwordx4 v68, s[44:47], s60 offen offset:0 lds
    buffer_load_dwordx4 v69, s[44:47], s60 offen offset:1024 lds
    buffer_load_dwordx4 v70, s[44:47], s60 offen offset:2048 lds
    buffer_load_dwordx4 v71, s[44:47], s60 offen offset:3072 lds
    s_add_u32 s60, s60, 65536
    s_sub_u32 s35, s35, 1
    s_cmp_eq_u32 s35, 0
    s_cselect_b32 s38, 1835008, 0
    s_sub_u32 s60, s60, s38
    s_sub_u32 s64, s64, 1
    s_cmp_lg_u32 s64, 0
    s_cbranch_scc1 L_b1
    s_lshl_b32 s60, s62, 16
    s_mov_b32 s64, 8
L_b3:
    s_waitcnt vmcnt(48)
    s_barrier
    s_mov_b32 m0, s61
    s_add_u32 s39, s61, 4096
    buffer_load_dwordx4 v72, s[48:51], s60 offen offset:0 lds
    buffer_load_dwordx4 v73, s[48:51], s60 offen offset:1024 lds
    buffer_load_dwordx4 v74, s[48:51], s60 offen offset:2048 lds
    buffer_load_dwordx4 v75, s[48:51], s60 offen offset:3072 lds
    s_mov_b32 m0, s39
    s_add_u32 s61, s61, 8192
    s_cmp_ge_u32 s61, 131072
    s_cselect_b32 s38, 90112, 0
    s_sub_u32 s61, s61, s38
    buffer_load_dwordx4 v76, s[48:51], s60 offen offset:0 lds
    buffer_load_dwordx4 v77, s[48:51], s60 offen offset:1024 lds
    buffer_load_dwordx4 v78, s[48:51], s60 offen offset:2048 lds
    buffer_load_dwordx4 v79, s[48:51], s60 offen offset:3072 lds
    s_waitcnt vmcnt(48)
    s_barrier
    s_mov_b32 m0, s61
    s_add_u32 s39, s61, 4096
    buffer_load_dwordx4 v72, s[52:55], s60 offen offset:0 lds
    buffer_load_dwordx4 v73, s[52:55], s60 offen offset:1024 lds
    buffer_load_dwordx4 v74, s[52:55], s60 offen offset:2048 lds
    buffer_load_dwordx4 v75, s[52:55], s60 offen offset:3072 lds
    s_mov_b32 m0, s39
    s_add_u32 s61, s61, 8192
    s_cmp_ge_u32 s61, 131072
    s_cselect_b32 s38, 90112, 0
    s_sub_u32 s61, s61, s38
    buffer_load_dwordx4 v76, s[52:55], s60 offen offset:0 lds
    buffer_load_dwordx4 v77, s[52:55], s60 offen offset:1024 lds
    buffer_load_dwordx4 v78, s[52:55], s60 offen offset:2048 lds
    buffer_load_dwordx4 v79, s[52:55], s60 offen offset:3072 lds
    s_add_u32 s60, s60, 128
    s_sub_u32 s64, s64, 1
    s_cmp_lg_u32 s64, 0
    s_cbranch_scc1 L_b3
    s_waitcnt vmcnt(48)
    s_barrier
    s_waitcnt vmcnt(40)
    s_barrier
    s_waitcnt vmcnt(32)
    s_barrier
    s_waitcnt vmcnt(24)
    s_barrier
    s_waitcnt vmcnt(16)
    s_barrier
    s_waitcnt vmcnt(8)
    s_barrier
    s_waitcnt vmcnt(0)
    s_barrier
    s_endpgm
L_helper:
    s_setprio 3
    s_waitcnt vmcnt(0)
    v_lshlrev_b32 v40, 16, v40
    v_lshlrev_b32 v41, 16, v41
    v_lshlrev_b32 v42, 16, v42
    v_mul_f32 v20, 1069066811, v42
    v_exp_f32 v20, v20
    s_nop 1
    v_cvt_pk_bf16_f32 v20, v20, v20
    v_lshlrev_b32 v20, 16, v20
    v_mul_f32 v21, v20, v40
    v_mul_f32 v22, v20, v41
    v_mul_f32 v21, 1069066811, v21
    v_exp_f32 v21, v21
    v_mul_f32 v22, 1042479491, v22
    v_rndne_f32 v23, v22
    v_sub_f32 v22, v22, v23
    v_cos_f32 v23, v22
    v_sin_f32 v24, v22
    s_nop 1
    v_mul_f32 v44, v21, v23
    v_mul_f32 v45, v21, v24
    v_mul_f32 v20, v45, v45
    v_mul_f32 v21, v44, v45
    v_fma_f32 v48, v44, v44, -v20
    v_add_f32 v49, v21, v21
    v_mul_f32 v20, v49, v49
    v_mul_f32 v21, v48, v49
    v_fma_f32 v48, v48, v48, -v20
    v_add_f32 v49, v21, v21
    v_mul_f32 v20, v49, v49
    v_mul_f32 v21, v48, v49
    v_fma_f32 v48, v48, v48, -v20
    v_add_f32 v49, v21, v21
    v_mul_f32 v20, v49, v49
    v_mul_f32 v21, v48, v49
    v_fma_f32 v50, v48, v48, -v20
    v_add_f32 v51, v21, v21
    v_mul_f32 v20, v51, v51
    v_mul_f32 v21, v50, v51
    v_fma_f32 v50, v50, v50, -v20
    v_add_f32 v51, v21, v21
    v_mul_f32 v20, v51, v51
    v_mul_f32 v21, v50, v51
    v_fma_f32 v50, v50, v50, -v20
    v_add_f32 v51, v21, v21
    v_mul_f32 v20, v51, v51
    v_mul_f32 v21, v50, v51
    v_fma_f32 v50, v50, v50, -v20
    v_add_f32 v51, v21, v21
    v_and_b32 v20, 31, v0
    v_lshlrev_b32 v21, 3, v20
    v_add_u32 v21, 131072, v21
    v_lshlrev_b32 v20, 4, v20
    v_mov_b32 v22, 135180
    s_mov_b32 s65, 262144
L_espin:
    ds_read_b32 v23, v22
    s_waitcnt lgkmcnt(0)
    v_readfirstlane_b32 s38, v23
    s_cmp_ge_u32 s38, 4
    s_cbranch_scc1 L_espin_ok
    s_sub_u32 s65, s65, 1
    s_cmp_lg_u32 s65, 0
    s_cbranch_scc1 L_espin
L_espin_ok:
    ds_read_b64 v[128:129], v21 offset:0
    ds_read_b64 v[130:131], v21 offset:256
    ds_read_b64 v[132:133], v21 offset:512
    ds_read_b64 v[134:135], v21 offset:768
    ds_read_b64 v[136:137], v21 offset:1024
    ds_read_b64 v[138:139], v21 offset:1280
    ds_read_b64 v[140:141], v21 offset:1536
    ds_read_b64 v[142:143], v21 offset:1792
    ds_read_b64 v[144:145], v21 offset:2048
    ds_read_b64 v[146:147], v21 offset:2304
    ds_read_b64 v[148:149], v21 offset:2560
    ds_read_b64 v[150:151], v21 offset:2816
    ds_read_b64 v[152:153], v21 offset:3072
    ds_read_b64 v[154:155], v21 offset:3328
    ds_read_b64 v[156:157], v21 offset:3584
    ds_read_b64 v[158:159], v21 offset:3840
    s_waitcnt lgkmcnt(0)
    v_mov_b32 v24, v128
    v_mov_b32 v25, v129
    v_fma_f32 v28, v48, v24, v130
    v_fma_f32 v29, v48, v25, v131
    v_fma_f32 v28, -v49, v25, v28
    v_fma_f32 v29, v49, v24, v29
    v_fma_f32 v24, v48, v28, v132
    v_fma_f32 v25, v48, v29, v133
    v_fma_f32 v24, -v49, v29, v24
    v_fma_f32 v25, v49, v28, v25
    v_fma_f32 v28, v48, v24, v134
    v_fma_f32 v29, v48, v25, v135
    v_fma_f32 v28, -v49, v25, v28
    v_fma_f32 v29, v49, v24, v29
    v_fma_f32 v24, v48, v28, v136
    v_fma_f32 v25, v48, v29, v137
    v_fma_f32 v24, -v49, v29, v24
    v_fma_f32 v25, v49, v28, v25
    v_fma_f32 v28, v48, v24, v138
    v_fma_f32 v29, v48, v25, v139
    v_fma_f32 v28, -v49, v25, v28
    v_fma_f32 v29, v49, v24, v29
    v_fma_f32 v24, v48, v28, v140
    v_fma_f32 v25, v48, v29, v141
    v_fma_f32 v24, -v49, v29, v24
    v_fma_f32 v25, v49, v28, v25
    v_fma_f32 v28, v48, v24, v142
    v_fma_f32 v29, v48, v25, v143
    v_fma_f32 v28, -v49, v25, v28
    v_fma_f32 v29, v49, v24, v29
    v_fma_f32 v24, v48, v28, v144
    v_fma_f32 v25, v48, v29, v145
    v_fma_f32 v24, -v49, v29, v24
    v_fma_f32 v25, v49, v28, v25
    v_fma_f32 v28, v48, v24, v146
    v_fma_f32 v29, v48, v25, v147
    v_fma_f32 v28, -v49, v25, v28
    v_fma_f32 v29, v49, v24, v29
    v_fma_f32 v24, v48, v28, v148
    v_fma_f32 v25, v48, v29, v149
    v_fma_f32 v24, -v49, v29, v24
    v_fma_f32 v25, v49, v28, v25
    v_fma_f32 v28, v48, v24, v150
    v_fma_f32 v29, v48, v25, v151
    v_fma_f32 v28, -v49, v25, v28
    v_fma_f32 v29, v49, v24, v29
    v_fma_f32 v24, v48, v28, v152
    v_fma_f32 v25, v48, v29, v153
    v_fma_f32 v24, -v49, v29, v24
    v_fma_f32 v25, v49, v28, v25
    v_fma_f32 v28, v48, v24, v154
    v_fma_f32 v29, v48, v25, v155
    v_fma_f32 v28, -v49, v25, v28
    v_fma_f32 v29, v49, v24, v29
    v_fma_f32 v24, v48, v28, v156
    v_fma_f32 v25, v48, v29, v157
    v_fma_f32 v24, -v49, v29, v24
    v_fma_f32 v25, v49, v28, v25
    v_fma_f32 v28, v48, v24, v158
    v_fma_f32 v29, v48, v25, v159
    v_fma_f32 v28, -v49, v25, v28
    v_fma_f32 v29, v49, v24, v29
    v_mov_b32 v30, s69
    v_mov_b32 v31, s69
    s_lshl_b32 s38, s32, 13
    s_lshl_b32 s39, s33, 9
    s_add_u32 s38, s38, s39
    s_add_u32 s38, s38, 14745600
    buffer_store_dwordx4 v[28:31], v20, s[40:43], s38 offen sc1
    v_mov_b32 v24, 0
    v_mov_b32 v25, 0
    s_cmp_eq_u32 s32, 0
    s_cbranch_scc1 L_hdone
    s_mov_b32 s64, 262144
    s_sleep 12
L_sretry:
    s_lshl_b32 s38, s33, 9
    s_add_u32 s38, s38, 14745600
    buffer_load_dwordx4 v[160:163], v20, s[40:43], s38 offen sc1
    s_add_u32 s38, s38, 8192
    s_cmp_gt_u32 s32, 1
    s_cbranch_scc0 L_sld_done
    buffer_load_dwordx4 v[164:167], v20, s[40:43], s38 offen sc1
    s_add_u32 s38, s38, 8192
    s_cmp_gt_u32 s32, 2
    s_cbranch_scc0 L_sld_done
    buffer_load_dwordx4 v[168:171], v20, s[40:43], s38 offen sc1
    s_add_u32 s38, s38, 8192
    s_cmp_gt_u32 s32, 3
    s_cbranch_scc0 L_sld_done
    buffer_load_dwordx4 v[172:175], v20, s[40:43], s38 offen sc1
    s_add_u32 s38, s38, 8192
    s_cmp_gt_u32 s32, 4
    s_cbranch_scc0 L_sld_done
    buffer_load_dwordx4 v[176:179], v20, s[40:43], s38 offen sc1
    s_add_u32 s38, s38, 8192
    s_cmp_gt_u32 s32, 5
    s_cbranch_scc0 L_sld_done
    buffer_load_dwordx4 v[180:183], v20, s[40:43], s38 offen sc1
    s_add_u32 s38, s38, 8192
    s_cmp_gt_u32 s32, 6
    s_cbranch_scc0 L_sld_done
    buffer_load_dwordx4 v[184:187], v20, s[40:43], s38 offen sc1
    s_add_u32 s38, s38, 8192
    s_cmp_gt_u32 s32, 7
    s_cbranch_scc0 L_sld_done
    buffer_load_dwordx4 v[188:191], v20, s[40:43], s38 offen sc1
    s_add_u32 s38, s38, 8192
    s_cmp_gt_u32 s32, 8
    s_cbranch_scc0 L_sld_done
    buffer_load_dwordx4 v[192:195], v20, s[40:43], s38 offen sc1
    s_add_u32 s38, s38, 8192
    s_cmp_gt_u32 s32, 9
    s_cbranch_scc0 L_sld_done
    buffer_load_dwordx4 v[196:199], v20, s[40:43], s38 offen sc1
    s_add_u32 s38, s38, 8192
    s_cmp_gt_u32 s32, 10
    s_cbranch_scc0 L_sld_done
    buffer_load_dwordx4 v[200:203], v20, s[40:43], s38 offen sc1
    s_add_u32 s38, s38, 8192
    s_cmp_gt_u32 s32, 11
    s_cbranch_scc0 L_sld_done
    buffer_load_dwordx4 v[204:207], v20, s[40:43], s38 offen sc1
    s_add_u32 s38, s38, 8192
    s_cmp_gt_u32 s32, 12
    s_cbranch_scc0 L_sld_done
    buffer_load_dwordx4 v[208:211], v20, s[40:43], s38 offen sc1
    s_add_u32 s38, s38, 8192
    s_cmp_gt_u32 s32, 13
    s_cbranch_scc0 L_sld_done
    buffer_load_dwordx4 v[212:215], v20, s[40:43], s38 offen sc1
    s_add_u32 s38, s38, 8192
    s_cmp_gt_u32 s32, 14
    s_cbranch_scc0 L_sld_done
    buffer_load_dwordx4 v[216:219], v20, s[40:43], s38 offen sc1
    s_add_u32 s38, s38, 8192
L_sld_done:
    s_waitcnt vmcnt(0)
    s_mov_b64 s[58:59], 0
    s_cmp_gt_u32 s32, 0
    s_cbranch_scc0 L_schk_done
    v_cmp_ne_u32 vcc, s69, v162
    s_or_b64 s[58:59], s[58:59], vcc
    s_cmp_gt_u32 s32, 1
    s_cbranch_scc0 L_schk_done
    v_cmp_ne_u32 vcc, s69, v166
    s_or_b64 s[58:59], s[58:59], vcc
    s_cmp_gt_u32 s32, 2
    s_cbranch_scc0 L_schk_done
    v_cmp_ne_u32 vcc, s69, v170
    s_or_b64 s[58:59], s[58:59], vcc
    s_cmp_gt_u32 s32, 3
    s_cbranch_scc0 L_schk_done
    v_cmp_ne_u32 vcc, s69, v174
    s_or_b64 s[58:59], s[58:59], vcc
    s_cmp_gt_u32 s32, 4
    s_cbranch_scc0 L_schk_done
    v_cmp_ne_u32 vcc, s69, v178
    s_or_b64 s[58:59], s[58:59], vcc
    s_cmp_gt_u32 s32, 5
    s_cbranch_scc0 L_schk_done
    v_cmp_ne_u32 vcc, s69, v182
    s_or_b64 s[58:59], s[58:59], vcc
    s_cmp_gt_u32 s32, 6
    s_cbranch_scc0 L_schk_done
    v_cmp_ne_u32 vcc, s69, v186
    s_or_b64 s[58:59], s[58:59], vcc
    s_cmp_gt_u32 s32, 7
    s_cbranch_scc0 L_schk_done
    v_cmp_ne_u32 vcc, s69, v190
    s_or_b64 s[58:59], s[58:59], vcc
    s_cmp_gt_u32 s32, 8
    s_cbranch_scc0 L_schk_done
    v_cmp_ne_u32 vcc, s69, v194
    s_or_b64 s[58:59], s[58:59], vcc
    s_cmp_gt_u32 s32, 9
    s_cbranch_scc0 L_schk_done
    v_cmp_ne_u32 vcc, s69, v198
    s_or_b64 s[58:59], s[58:59], vcc
    s_cmp_gt_u32 s32, 10
    s_cbranch_scc0 L_schk_done
    v_cmp_ne_u32 vcc, s69, v202
    s_or_b64 s[58:59], s[58:59], vcc
    s_cmp_gt_u32 s32, 11
    s_cbranch_scc0 L_schk_done
    v_cmp_ne_u32 vcc, s69, v206
    s_or_b64 s[58:59], s[58:59], vcc
    s_cmp_gt_u32 s32, 12
    s_cbranch_scc0 L_schk_done
    v_cmp_ne_u32 vcc, s69, v210
    s_or_b64 s[58:59], s[58:59], vcc
    s_cmp_gt_u32 s32, 13
    s_cbranch_scc0 L_schk_done
    v_cmp_ne_u32 vcc, s69, v214
    s_or_b64 s[58:59], s[58:59], vcc
    s_cmp_gt_u32 s32, 14
    s_cbranch_scc0 L_schk_done
    v_cmp_ne_u32 vcc, s69, v218
    s_or_b64 s[58:59], s[58:59], vcc
L_schk_done:
    s_cmp_eq_u64 s[58:59], 0
    s_cbranch_scc1 L_sok
    s_sub_u32 s64, s64, 1
    s_cmp_lg_u32 s64, 0
    s_cbranch_scc1 L_sretry
L_sok:
    s_cmp_gt_u32 s32, 0
    s_cbranch_scc0 L_hdone
    v_fma_f32 v28, v50, v24, v160
    v_fma_f32 v29, v50, v25, v161
    v_fma_f32 v28, -v51, v25, v28
    v_fma_f32 v29, v51, v24, v29
    v_mov_b32 v24, v28
    v_mov_b32 v25, v29
    s_cmp_gt_u32 s32, 1
    s_cbranch_scc0 L_hdone
    v_fma_f32 v28, v50, v24, v164
    v_fma_f32 v29, v50, v25, v165
    v_fma_f32 v28, -v51, v25, v28
    v_fma_f32 v29, v51, v24, v29
    v_mov_b32 v24, v28
    v_mov_b32 v25, v29
    s_cmp_gt_u32 s32, 2
    s_cbranch_scc0 L_hdone
    v_fma_f32 v28, v50, v24, v168
    v_fma_f32 v29, v50, v25, v169
    v_fma_f32 v28, -v51, v25, v28
    v_fma_f32 v29, v51, v24, v29
    v_mov_b32 v24, v28
    v_mov_b32 v25, v29
    s_cmp_gt_u32 s32, 3
    s_cbranch_scc0 L_hdone
    v_fma_f32 v28, v50, v24, v172
    v_fma_f32 v29, v50, v25, v173
    v_fma_f32 v28, -v51, v25, v28
    v_fma_f32 v29, v51, v24, v29
    v_mov_b32 v24, v28
    v_mov_b32 v25, v29
    s_cmp_gt_u32 s32, 4
    s_cbranch_scc0 L_hdone
    v_fma_f32 v28, v50, v24, v176
    v_fma_f32 v29, v50, v25, v177
    v_fma_f32 v28, -v51, v25, v28
    v_fma_f32 v29, v51, v24, v29
    v_mov_b32 v24, v28
    v_mov_b32 v25, v29
    s_cmp_gt_u32 s32, 5
    s_cbranch_scc0 L_hdone
    v_fma_f32 v28, v50, v24, v180
    v_fma_f32 v29, v50, v25, v181
    v_fma_f32 v28, -v51, v25, v28
    v_fma_f32 v29, v51, v24, v29
    v_mov_b32 v24, v28
    v_mov_b32 v25, v29
    s_cmp_gt_u32 s32, 6
    s_cbranch_scc0 L_hdone
    v_fma_f32 v28, v50, v24, v184
    v_fma_f32 v29, v50, v25, v185
    v_fma_f32 v28, -v51, v25, v28
    v_fma_f32 v29, v51, v24, v29
    v_mov_b32 v24, v28
    v_mov_b32 v25, v29
    s_cmp_gt_u32 s32, 7
    s_cbranch_scc0 L_hdone
    v_fma_f32 v28, v50, v24, v188
    v_fma_f32 v29, v50, v25, v189
    v_fma_f32 v28, -v51, v25, v28
    v_fma_f32 v29, v51, v24, v29
    v_mov_b32 v24, v28
    v_mov_b32 v25, v29
    s_cmp_gt_u32 s32, 8
    s_cbranch_scc0 L_hdone
    v_fma_f32 v28, v50, v24, v192
    v_fma_f32 v29, v50, v25, v193
    v_fma_f32 v28, -v51, v25, v28
    v_fma_f32 v29, v51, v24, v29
    v_mov_b32 v24, v28
    v_mov_b32 v25, v29
    s_cmp_gt_u32 s32, 9
    s_cbranch_scc0 L_hdone
    v_fma_f32 v28, v50, v24, v196
    v_fma_f32 v29, v50, v25, v197
    v_fma_f32 v28, -v51, v25, v28
    v_fma_f32 v29, v51, v24, v29
    v_mov_b32 v24, v28
    v_mov_b32 v25, v29
    s_cmp_gt_u32 s32, 10
    s_cbranch_scc0 L_hdone
    v_fma_f32 v28, v50, v24, v200
    v_fma_f32 v29, v50, v25, v201
    v_fma_f32 v28, -v51, v25, v28
    v_fma_f32 v29, v51, v24, v29
    v_mov_b32 v24, v28
    v_mov_b32 v25, v29
    s_cmp_gt_u32 s32, 11
    s_cbranch_scc0 L_hdone
    v_fma_f32 v28, v50, v24, v204
    v_fma_f32 v29, v50, v25, v205
    v_fma_f32 v28, -v51, v25, v28
    v_fma_f32 v29, v51, v24, v29
    v_mov_b32 v24, v28
    v_mov_b32 v25, v29
    s_cmp_gt_u32 s32, 12
    s_cbranch_scc0 L_hdone
    v_fma_f32 v28, v50, v24, v208
    v_fma_f32 v29, v50, v25, v209
    v_fma_f32 v28, -v51, v25, v28
    v_fma_f32 v29, v51, v24, v29
    v_mov_b32 v24, v28
    v_mov_b32 v25, v29
    s_cmp_gt_u32 s32, 13
    s_cbranch_scc0 L_hdone
    v_fma_f32 v28, v50, v24, v212
    v_fma_f32 v29, v50, v25, v213
    v_fma_f32 v28, -v51, v25, v28
    v_fma_f32 v29, v51, v24, v29
    v_mov_b32 v24, v28
    v_mov_b32 v25, v29
    s_cmp_gt_u32 s32, 14
    s_cbranch_scc0 L_hdone
    v_fma_f32 v28, v50, v24, v216
    v_fma_f32 v29, v50, v25, v217
    v_fma_f32 v28, -v51, v25, v28
    v_fma_f32 v29, v51, v24, v29
    v_mov_b32 v24, v28
    v_mov_b32 v25, v29
L_hdone:
    ds_write_b64 v21, v[24:25] offset:0
    v_fma_f32 v28, v48, v24, v128
    v_fma_f32 v29, v48, v25, v129
    v_fma_f32 v28, -v49, v25, v28
    v_fma_f32 v29, v49, v24, v29
    ds_write_b64 v21, v[28:29] offset:256
    v_fma_f32 v24, v48, v28, v130
    v_fma_f32 v25, v48, v29, v131
    v_fma_f32 v24, -v49, v29, v24
    v_fma_f32 v25, v49, v28, v25
    ds_write_b64 v21, v[24:25] offset:512
    v_fma_f32 v28, v48, v24, v132
    v_fma_f32 v29, v48, v25, v133
    v_fma_f32 v28, -v49, v25, v28
    v_fma_f32 v29, v49, v24, v29
    ds_write_b64 v21, v[28:29] offset:768
    v_fma_f32 v24, v48, v28, v134
    v_fma_f32 v25, v48, v29, v135
    v_fma_f32 v24, -v49, v29, v24
    v_fma_f32 v25, v49, v28, v25
    ds_write_b64 v21, v[24:25] offset:1024
    v_fma_f32 v28, v48, v24, v136
    v_fma_f32 v29, v48, v25, v137
    v_fma_f32 v28, -v49, v25, v28
    v_fma_f32 v29, v49, v24, v29
    ds_write_b64 v21, v[28:29] offset:1280
    v_fma_f32 v24, v48, v28, v138
    v_fma_f32 v25, v48, v29, v139
    v_fma_f32 v24, -v49, v29, v24
    v_fma_f32 v25, v49, v28, v25
    ds_write_b64 v21, v[24:25] offset:1536
    v_fma_f32 v28, v48, v24, v140
    v_fma_f32 v29, v48, v25, v141
    v_fma_f32 v28, -v49, v25, v28
    v_fma_f32 v29, v49, v24, v29
    ds_write_b64 v21, v[28:29] offset:1792
    v_fma_f32 v24, v48, v28, v142
    v_fma_f32 v25, v48, v29, v143
    v_fma_f32 v24, -v49, v29, v24
    v_fma_f32 v25, v49, v28, v25
    ds_write_b64 v21, v[24:25] offset:2048
    v_fma_f32 v28, v48, v24, v144
    v_fma_f32 v29, v48, v25, v145
    v_fma_f32 v28, -v49, v25, v28
    v_fma_f32 v29, v49, v24, v29
    ds_write_b64 v21, v[28:29] offset:2304
    v_fma_f32 v24, v48, v28, v146
    v_fma_f32 v25, v48, v29, v147
    v_fma_f32 v24, -v49, v29, v24
    v_fma_f32 v25, v49, v28, v25
    ds_write_b64 v21, v[24:25] offset:2560
    v_fma_f32 v28, v48, v24, v148
    v_fma_f32 v29, v48, v25, v149
    v_fma_f32 v28, -v49, v25, v28
    v_fma_f32 v29, v49, v24, v29
    ds_write_b64 v21, v[28:29] offset:2816
    v_fma_f32 v24, v48, v28, v150
    v_fma_f32 v25, v48, v29, v151
    v_fma_f32 v24, -v49, v29, v24
    v_fma_f32 v25, v49, v28, v25
    ds_write_b64 v21, v[24:25] offset:3072
    v_fma_f32 v28, v48, v24, v152
    v_fma_f32 v29, v48, v25, v153
    v_fma_f32 v28, -v49, v25, v28
    v_fma_f32 v29, v49, v24, v29
    ds_write_b64 v21, v[28:29] offset:3328
    v_fma_f32 v24, v48, v28, v154
    v_fma_f32 v25, v48, v29, v155
    v_fma_f32 v24, -v49, v29, v24
    v_fma_f32 v25, v49, v28, v25
    ds_write_b64 v21, v[24:25] offset:3584
    v_fma_f32 v28, v48, v24, v156
    v_fma_f32 v29, v48, v25, v157
    v_fma_f32 v28, -v49, v25, v28
    v_fma_f32 v29, v49, v24, v29
    ds_write_b64 v21, v[28:29] offset:3840
    v_mov_b32 v22, 1
    v_mov_b32 v23, 135172
    s_waitcnt lgkmcnt(0)
    ds_write_b32 v23, v22
    s_waitcnt lgkmcnt(0)
    s_setprio 0
    s_mov_b32 s64, 44
L_hrest:
    s_barrier
    s_sub_u32 s64, s64, 1
    s_cmp_lg_u32 s64, 0
    s_cbranch_scc1 L_hrest
    s_endpgm
L_consumer:
    v_and_b32 v13, 15, v0
    v_lshrrev_b32 v14, 4, v0
    s_lshl_b32 s38, s33, 5
    v_add_u32 v15, s38, v13
    v_lshlrev_b32 v15, 1, v15
    s_waitcnt lgkmcnt(0)
    s_mov_b32 s44, s6
    s_and_b32 s45, s7, 0xffff
    s_mov_b32 s46, 1024
    s_mov_b32 s47, 0x20000
    buffer_load_ushort v216, v15, s[44:47], 0 offen
    buffer_load_ushort v219, v15, s[44:47], 0 offen offset:32
    s_mov_b32 s44, s8
    s_and_b32 s45, s9, 0xffff
    s_mov_b32 s46, 1024
    s_mov_b32 s47, 0x20000
    buffer_load_ushort v217, v15, s[44:47], 0 offen
    buffer_load_ushort v220, v15, s[44:47], 0 offen offset:32
    s_mov_b32 s44, s18
    s_and_b32 s45, s19, 0xffff
    s_mov_b32 s46, 1024
    s_mov_b32 s47, 0x20000
    buffer_load_ushort v218, v15, s[44:47], 0 offen
    buffer_load_ushort v221, v15, s[44:47], 0 offen offset:32
    s_mov_b32 s44, s22
    s_and_b32 s45, s23, 0xffff
    s_mov_b32 s46, 3584
    s_mov_b32 s47, 0x20000
    s_mul_i32 s38, s33, 224
    v_lshlrev_b32 v15, 3, v14
    v_add_u32 v15, s38, v15
    buffer_load_dwordx2 v[52:53], v15, s[44:47], 0 offen offset:0
    buffer_load_dwordx2 v[60:61], v15, s[44:47], 0 offen offset:32
    buffer_load_dwordx2 v[68:69], v15, s[44:47], 0 offen offset:64
    buffer_load_dwordx2 v[76:77], v15, s[44:47], 0 offen offset:96
    buffer_load_dwordx2 v[84:85], v15, s[44:47], 0 offen offset:128
    buffer_load_dwordx2 v[92:93], v15, s[44:47], 0 offen offset:160
    buffer_load_dwordx2 v[100:101], v15, s[44:47], 0 offen offset:192
    s_mov_b32 s40, s30
    s_and_b32 s41, s31, 0xffff
    s_mov_b32 s42, 16777216
    s_mov_b32 s43, 0x20000
    v_lshrrev_b32 v15, 2, v13
    v_lshlrev_b32 v1, 3, v15
    v_and_b32 v12, 3, v13
    v_add_u32 v1, v1, v12
    s_lshl_b32 s38, s34, 5
    v_add_u32 v1, s38, v1
    v_lshlrev_b32 v1, 7, v1
    v_lshrrev_b32 v12, 1, v13
    v_and_b32 v12, 1, v12
    v_lshlrev_b32 v15, 1, v15
    v_or_b32 v12, v12, v15
    v_add_u32 v15, 0, v14
    v_xor_b32 v15, v15, v12
    v_lshlrev_b32 v15, 4, v15
    v_add_u32 v2, v1, v15
    v_add_u32 v15, 4, v14
    v_xor_b32 v15, v15, v12
    v_lshlrev_b32 v15, 4, v15
    v_add_u32 v3, v1, v15
    v_lshlrev_b32 v1, 7, v13
    v_add_u32 v1, 49152, v1
    v_lshrrev_b32 v12, 1, v13
    v_add_u32 v15, 0, v14
    v_xor_b32 v15, v15, v12
    v_lshlrev_b32 v15, 4, v15
    v_add_u32 v4, v1, v15
    v_add_u32 v15, 4, v14
    v_xor_b32 v15, v15, v12
    v_lshlrev_b32 v15, 4, v15
    v_add_u32 v5, v1, v15
    v_lshrrev_b32 v15, 2, v13
    v_lshlrev_b32 v1, 3, v14
    v_add_u32 v1, v1, v15
    v_lshlrev_b32 v1, 8, v1
    v_add_u32 v1, 73728, v1
    v_and_b32 v12, 1, v13
    v_lshlrev_b32 v12, 3, v12
    v_add_u32 v1, v1, v12
    v_and_b32 v12, 1, v14
    v_lshlrev_b32 v12, 2, v12
    v_or_b32 v12, v12, v15
    v_lshlrev_b32 v12, 1, v12
    v_lshrrev_b32 v15, 1, v13
    v_and_b32 v15, 1, v15
    v_add_u32 v225, 0, v15
    v_xor_b32 v225, v225, v12
    v_lshlrev_b32 v225, 4, v225
    v_add_u32 v225, v1, v225
    v_add_u32 v226, 2, v15
    v_xor_b32 v226, v226, v12
    v_lshlrev_b32 v226, 4, v226
    v_add_u32 v226, v1, v226
    v_add_u32 v227, 4, v15
    v_xor_b32 v227, v227, v12
    v_lshlrev_b32 v227, 4, v227
    v_add_u32 v227, v1, v227
    v_add_u32 v228, 6, v15
    v_xor_b32 v228, v228, v12
    v_lshlrev_b32 v228, 4, v228
    v_add_u32 v228, v1, v228
    v_add_u32 v229, 8, v15
    v_xor_b32 v229, v229, v12
    v_lshlrev_b32 v229, 4, v229
    v_add_u32 v229, v1, v229
    v_add_u32 v230, 10, v15
    v_xor_b32 v230, v230, v12
    v_lshlrev_b32 v230, 4, v230
    v_add_u32 v230, v1, v230
    v_add_u32 v231, 12, v15
    v_xor_b32 v231, v231, v12
    v_lshlrev_b32 v231, 4, v231
    v_add_u32 v231, v1, v231
    v_mov_b32 v16, 0
    v_mov_b32 v17, 0
    v_mov_b32 v18, 0
    v_mov_b32 v19, 0
    v_mov_b32 v20, 0
    v_mov_b32 v21, 0
    v_mov_b32 v22, 0
    v_mov_b32 v23, 0
    v_mov_b32 v24, 0
    v_mov_b32 v25, 0
    v_mov_b32 v26, 0
    v_mov_b32 v27, 0
    v_mov_b32 v28, 0
    v_mov_b32 v29, 0
    v_mov_b32 v30, 0
    v_mov_b32 v31, 0
    v_mov_b32 v32, 0
    v_mov_b32 v33, 0
    v_mov_b32 v34, 0
    v_mov_b32 v35, 0
    v_mov_b32 v36, 0
    v_mov_b32 v37, 0
    v_mov_b32 v38, 0
    v_mov_b32 v39, 0
    v_mov_b32 v40, 0
    v_mov_b32 v41, 0
    v_mov_b32 v42, 0
    v_mov_b32 v43, 0
    v_mov_b32 v44, 0
    v_mov_b32 v45, 0
    v_mov_b32 v46, 0
    v_mov_b32 v47, 0
    s_waitcnt vmcnt(0)
    v_lshlrev_b32 v48, 16, v52
    v_and_b32 v49, 0xffff0000, v52
    v_lshlrev_b32 v50, 16, v53
    v_and_b32 v51, 0xffff0000, v53
    v_mov_b32 v52, v48
    v_mov_b32 v53, v49
    v_mov_b32 v54, v50
    v_mov_b32 v55, v51
    v_lshlrev_b32 v56, 16, v60
    v_and_b32 v57, 0xffff0000, v60
    v_lshlrev_b32 v58, 16, v61
    v_and_b32 v59, 0xffff0000, v61
    v_mov_b32 v60, v56
    v_mov_b32 v61, v57
    v_mov_b32 v62, v58
    v_mov_b32 v63, v59
    v_lshlrev_b32 v64, 16, v68
    v_and_b32 v65, 0xffff0000, v68
    v_lshlrev_b32 v66, 16, v69
    v_and_b32 v67, 0xffff0000, v69
    v_mov_b32 v68, v64
    v_mov_b32 v69, v65
    v_mov_b32 v70, v66
    v_mov_b32 v71, v67
    v_lshlrev_b32 v72, 16, v76
    v_and_b32 v73, 0xffff0000, v76
    v_lshlrev_b32 v74, 16, v77
    v_and_b32 v75, 0xffff0000, v77
    v_mov_b32 v76, v72
    v_mov_b32 v77, v73
    v_mov_b32 v78, v74
    v_mov_b32 v79, v75
    v_lshlrev_b32 v80, 16, v84
    v_and_b32 v81, 0xffff0000, v84
    v_lshlrev_b32 v82, 16, v85
    v_and_b32 v83, 0xffff0000, v85
    v_mov_b32 v84, v80
    v_mov_b32 v85, v81
    v_mov_b32 v86, v82
    v_mov_b32 v87, v83
    v_lshlrev_b32 v88, 16, v92
    v_and_b32 v89, 0xffff0000, v92
    v_lshlrev_b32 v90, 16, v93
    v_and_b32 v91, 0xffff0000, v93
    v_mov_b32 v92, v88
    v_mov_b32 v93, v89
    v_mov_b32 v94, v90
    v_mov_b32 v95, v91
    v_lshlrev_b32 v96, 16, v100
    v_and_b32 v97, 0xffff0000, v100
    v_lshlrev_b32 v98, 16, v101
    v_and_b32 v99, 0xffff0000, v101
    v_mov_b32 v100, v96
    v_mov_b32 v101, v97
    v_mov_b32 v102, v98
    v_mov_b32 v103, v99
    s_barrier
    ds_read_b128 v[104:107], v2 offset:0
    ds_read_b128 v[108:111], v2 offset:512
    ds_read_b64_tr_b16 v[128:129], v225 offset:0
    ds_read_b64_tr_b16 v[130:131], v225 offset:1024
    ds_read_b64_tr_b16 v[132:133], v226 offset:0
    ds_read_b64_tr_b16 v[134:135], v226 offset:1024
    ds_read_b64_tr_b16 v[136:137], v227 offset:0
    ds_read_b64_tr_b16 v[138:139], v227 offset:1024
    ds_read_b64_tr_b16 v[140:141], v228 offset:0
    ds_read_b64_tr_b16 v[142:143], v228 offset:1024
    ds_read_b64_tr_b16 v[144:145], v229 offset:0
    ds_read_b64_tr_b16 v[146:147], v229 offset:1024
    ds_read_b64_tr_b16 v[148:149], v230 offset:0
    ds_read_b64_tr_b16 v[150:151], v230 offset:1024
    ds_read_b64_tr_b16 v[152:153], v231 offset:0
    ds_read_b64_tr_b16 v[154:155], v231 offset:1024
    ds_read_b128 v[112:115], v4 offset:0
    ds_read_b128 v[116:119], v4 offset:2048
    ds_read_b128 v[120:123], v4 offset:4096
    ds_read_b128 v[124:127], v4 offset:6144
    s_waitcnt lgkmcnt(15)
    v_mfma_f32_16x16x32_bf16 v[48:51], v[128:131], v[104:107], v[48:51]
    ds_read_b128 v[156:159], v3 offset:0
    ds_read_b128 v[160:163], v3 offset:512
    v_mfma_f32_16x16x32_bf16 v[52:55], v[128:131], v[108:111], v[52:55]
    ds_read_b64_tr_b16 v[180:181], v225 offset:8192
    ds_read_b64_tr_b16 v[182:183], v225 offset:9216
    s_waitcnt lgkmcnt(15)
    v_mfma_f32_16x16x32_bf16 v[56:59], v[132:135], v[104:107], v[56:59]
    ds_read_b64_tr_b16 v[184:185], v226 offset:8192
    ds_read_b64_tr_b16 v[186:187], v226 offset:9216
    v_mfma_f32_16x16x32_bf16 v[60:63], v[132:135], v[108:111], v[60:63]
    ds_read_b64_tr_b16 v[188:189], v227 offset:8192
    ds_read_b64_tr_b16 v[190:191], v227 offset:9216
    s_waitcnt lgkmcnt(15)
    v_mfma_f32_16x16x32_bf16 v[64:67], v[136:139], v[104:107], v[64:67]
    ds_read_b64_tr_b16 v[192:193], v228 offset:8192
    v_mfma_f32_16x16x32_bf16 v[68:71], v[136:139], v[108:111], v[68:71]
    ds_read_b64_tr_b16 v[194:195], v228 offset:9216
    s_waitcnt lgkmcnt(15)
    v_mfma_f32_16x16x32_bf16 v[72:75], v[140:143], v[104:107], v[72:75]
    ds_read_b64_tr_b16 v[196:197], v229 offset:8192
    v_mfma_f32_16x16x32_bf16 v[76:79], v[140:143], v[108:111], v[76:79]
    ds_read_b64_tr_b16 v[198:199], v229 offset:9216
    s_waitcnt lgkmcnt(15)
    v_mfma_f32_16x16x32_bf16 v[80:83], v[144:147], v[104:107], v[80:83]
    ds_read_b64_tr_b16 v[200:201], v230 offset:8192
    v_mfma_f32_16x16x32_bf16 v[84:87], v[144:147], v[108:111], v[84:87]
    ds_read_b64_tr_b16 v[202:203], v230 offset:9216
    s_waitcnt lgkmcnt(15)
    v_mfma_f32_16x16x32_bf16 v[88:91], v[148:151], v[104:107], v[88:91]
    ds_read_b64_tr_b16 v[204:205], v231 offset:8192
    v_mfma_f32_16x16x32_bf16 v[92:95], v[148:151], v[108:111], v[92:95]
    ds_read_b64_tr_b16 v[206:207], v231 offset:9216
    s_waitcnt lgkmcnt(15)
    v_mfma_f32_16x16x32_bf16 v[96:99], v[152:155], v[104:107], v[96:99]
    ds_read_b128 v[164:167], v5 offset:0
    v_mfma_f32_16x16x32_bf16 v[100:103], v[152:155], v[108:111], v[100:103]
    ds_read_b128 v[168:171], v5 offset:2048
    s_waitcnt lgkmcnt(15)
    v_mfma_f32_16x16x32_bf16 v[16:19], v[104:107], v[112:115], v[16:19]
    ds_read_b128 v[172:175], v5 offset:4096
    v_mfma_f32_16x16x32_bf16 v[32:35], v[108:111], v[112:115], v[32:35]
    ds_read_b128 v[176:179], v5 offset:6144
    s_waitcnt lgkmcnt(15)
    v_mfma_f32_16x16x32_bf16 v[20:23], v[104:107], v[116:119], v[20:23]
    v_mfma_f32_16x16x32_bf16 v[36:39], v[108:111], v[116:119], v[36:39]
    s_waitcnt lgkmcnt(15)
    v_mfma_f32_16x16x32_bf16 v[24:27], v[104:107], v[120:123], v[24:27]
    v_mfma_f32_16x16x32_bf16 v[40:43], v[108:111], v[120:123], v[40:43]
    s_waitcnt lgkmcnt(15)
    v_mfma_f32_16x16x32_bf16 v[28:31], v[104:107], v[124:127], v[28:31]
    v_mfma_f32_16x16x32_bf16 v[44:47], v[108:111], v[124:127], v[44:47]
    s_waitcnt lgkmcnt(0)
    s_barrier
    v_mfma_f32_16x16x32_bf16 v[48:51], v[180:183], v[156:159], v[48:51]
    ds_read_b128 v[104:107], v2 offset:16384
    ds_read_b128 v[108:111], v2 offset:16896
    v_mfma_f32_16x16x32_bf16 v[52:55], v[180:183], v[160:163], v[52:55]
    ds_read_b64_tr_b16 v[128:129], v225 offset:16384
    ds_read_b64_tr_b16 v[130:131], v225 offset:17408
    v_mfma_f32_16x16x32_bf16 v[56:59], v[184:187], v[156:159], v[56:59]
    ds_read_b64_tr_b16 v[132:133], v226 offset:16384
    ds_read_b64_tr_b16 v[134:135], v226 offset:17408
    v_mfma_f32_16x16x32_bf16 v[60:63], v[184:187], v[160:163], v[60:63]
    ds_read_b64_tr_b16 v[136:137], v227 offset:16384
    ds_read_b64_tr_b16 v[138:139], v227 offset:17408
    v_mfma_f32_16x16x32_bf16 v[64:67], v[188:191], v[156:159], v[64:67]
    ds_read_b64_tr_b16 v[140:141], v228 offset:16384
    v_mfma_f32_16x16x32_bf16 v[68:71], v[188:191], v[160:163], v[68:71]
    ds_read_b64_tr_b16 v[142:143], v228 offset:17408
    v_mfma_f32_16x16x32_bf16 v[72:75], v[192:195], v[156:159], v[72:75]
    ds_read_b64_tr_b16 v[144:145], v229 offset:16384
    v_mfma_f32_16x16x32_bf16 v[76:79], v[192:195], v[160:163], v[76:79]
    ds_read_b64_tr_b16 v[146:147], v229 offset:17408
    v_mfma_f32_16x16x32_bf16 v[80:83], v[196:199], v[156:159], v[80:83]
    ds_read_b64_tr_b16 v[148:149], v230 offset:16384
    v_mfma_f32_16x16x32_bf16 v[84:87], v[196:199], v[160:163], v[84:87]
    ds_read_b64_tr_b16 v[150:151], v230 offset:17408
    v_mfma_f32_16x16x32_bf16 v[88:91], v[200:203], v[156:159], v[88:91]
    ds_read_b64_tr_b16 v[152:153], v231 offset:16384
    v_mfma_f32_16x16x32_bf16 v[92:95], v[200:203], v[160:163], v[92:95]
    ds_read_b64_tr_b16 v[154:155], v231 offset:17408
    v_mfma_f32_16x16x32_bf16 v[96:99], v[204:207], v[156:159], v[96:99]
    ds_read_b128 v[112:115], v4 offset:8192
    v_mfma_f32_16x16x32_bf16 v[100:103], v[204:207], v[160:163], v[100:103]
    ds_read_b128 v[116:119], v4 offset:10240
    v_mfma_f32_16x16x32_bf16 v[16:19], v[156:159], v[164:167], v[16:19]
    ds_read_b128 v[120:123], v4 offset:12288
    v_mfma_f32_16x16x32_bf16 v[32:35], v[160:163], v[164:167], v[32:35]
    ds_read_b128 v[124:127], v4 offset:14336
    v_mfma_f32_16x16x32_bf16 v[20:23], v[156:159], v[168:171], v[20:23]
    v_mfma_f32_16x16x32_bf16 v[36:39], v[160:163], v[168:171], v[36:39]
    v_mfma_f32_16x16x32_bf16 v[24:27], v[156:159], v[172:175], v[24:27]
    v_mfma_f32_16x16x32_bf16 v[40:43], v[160:163], v[172:175], v[40:43]
    v_mfma_f32_16x16x32_bf16 v[28:31], v[156:159], v[176:179], v[28:31]
    v_mfma_f32_16x16x32_bf16 v[44:47], v[160:163], v[176:179], v[44:47]
    s_waitcnt lgkmcnt(15)
    v_mfma_f32_16x16x32_bf16 v[48:51], v[128:131], v[104:107], v[48:51]
    ds_read_b128 v[156:159], v3 offset:16384
    ds_read_b128 v[160:163], v3 offset:16896
    v_mfma_f32_16x16x32_bf16 v[52:55], v[128:131], v[108:111], v[52:55]
    ds_read_b64_tr_b16 v[180:181], v225 offset:24576
    ds_read_b64_tr_b16 v[182:183], v225 offset:25600
    s_waitcnt lgkmcnt(15)
    v_mfma_f32_16x16x32_bf16 v[56:59], v[132:135], v[104:107], v[56:59]
    ds_read_b64_tr_b16 v[184:185], v226 offset:24576
    ds_read_b64_tr_b16 v[186:187], v226 offset:25600
    v_mfma_f32_16x16x32_bf16 v[60:63], v[132:135], v[108:111], v[60:63]
    ds_read_b64_tr_b16 v[188:189], v227 offset:24576
    ds_read_b64_tr_b16 v[190:191], v227 offset:25600
    s_waitcnt lgkmcnt(15)
    v_mfma_f32_16x16x32_bf16 v[64:67], v[136:139], v[104:107], v[64:67]
    ds_read_b64_tr_b16 v[192:193], v228 offset:24576
    v_mfma_f32_16x16x32_bf16 v[68:71], v[136:139], v[108:111], v[68:71]
    ds_read_b64_tr_b16 v[194:195], v228 offset:25600
    s_waitcnt lgkmcnt(15)
    v_mfma_f32_16x16x32_bf16 v[72:75], v[140:143], v[104:107], v[72:75]
    ds_read_b64_tr_b16 v[196:197], v229 offset:24576
    v_mfma_f32_16x16x32_bf16 v[76:79], v[140:143], v[108:111], v[76:79]
    ds_read_b64_tr_b16 v[198:199], v229 offset:25600
    s_waitcnt lgkmcnt(15)
    v_mfma_f32_16x16x32_bf16 v[80:83], v[144:147], v[104:107], v[80:83]
    ds_read_b64_tr_b16 v[200:201], v230 offset:24576
    v_mfma_f32_16x16x32_bf16 v[84:87], v[144:147], v[108:111], v[84:87]
    ds_read_b64_tr_b16 v[202:203], v230 offset:25600
    s_waitcnt lgkmcnt(15)
    v_mfma_f32_16x16x32_bf16 v[88:91], v[148:151], v[104:107], v[88:91]
    ds_read_b64_tr_b16 v[204:205], v231 offset:24576
    v_mfma_f32_16x16x32_bf16 v[92:95], v[148:151], v[108:111], v[92:95]
    ds_read_b64_tr_b16 v[206:207], v231 offset:25600
    s_waitcnt lgkmcnt(15)
    v_mfma_f32_16x16x32_bf16 v[96:99], v[152:155], v[104:107], v[96:99]
    ds_read_b128 v[164:167], v5 offset:8192
    v_mfma_f32_16x16x32_bf16 v[100:103], v[152:155], v[108:111], v[100:103]
    ds_read_b128 v[168:171], v5 offset:10240
    s_waitcnt lgkmcnt(15)
    v_mfma_f32_16x16x32_bf16 v[16:19], v[104:107], v[112:115], v[16:19]
    ds_read_b128 v[172:175], v5 offset:12288
    v_mfma_f32_16x16x32_bf16 v[32:35], v[108:111], v[112:115], v[32:35]
    ds_read_b128 v[176:179], v5 offset:14336
    s_waitcnt lgkmcnt(15)
    v_mfma_f32_16x16x32_bf16 v[20:23], v[104:107], v[116:119], v[20:23]
    v_mfma_f32_16x16x32_bf16 v[36:39], v[108:111], v[116:119], v[36:39]
    s_waitcnt lgkmcnt(15)
    v_mfma_f32_16x16x32_bf16 v[24:27], v[104:107], v[120:123], v[24:27]
    v_mfma_f32_16x16x32_bf16 v[40:43], v[108:111], v[120:123], v[40:43]
    s_waitcnt lgkmcnt(15)
    v_mfma_f32_16x16x32_bf16 v[28:31], v[104:107], v[124:127], v[28:31]
    v_mfma_f32_16x16x32_bf16 v[44:47], v[108:111], v[124:127], v[44:47]
    s_waitcnt lgkmcnt(0)
    s_barrier
    v_lshlrev_b32 v216, 16, v216
    v_lshlrev_b32 v217, 16, v217
    v_lshlrev_b32 v218, 16, v218
    v_mul_f32 v234, 1069066811, v218
    v_exp_f32 v234, v234
    s_nop 1
    v_cvt_pk_bf16_f32 v234, v234, v234
    v_lshlrev_b32 v234, 16, v234
    v_mul_f32 v235, v234, v216
    v_mul_f32 v236, v234, v217
    v_mul_f32 v235, 1069066811, v235
    v_exp_f32 v235, v235
    v_mul_f32 v236, 1042479491, v236
    v_rndne_f32 v237, v236
    v_sub_f32 v236, v236, v237
    v_cos_f32 v237, v236
    v_sin_f32 v238, v236
    s_nop 1
    v_mul_f32 v208, v235, v237
    v_mul_f32 v209, v235, v238
    v_add_f32 v234, -1.0, v208
    v_mul_f32 v235, v216, v216
    v_fma_f32 v235, v217, v217, v235
    v_rcp_f32 v235, v235
    v_mul_f32 v236, v234, v216
    v_fma_f32 v236, v209, v217, v236
    v_mul_f32 v237, v209, v216
    v_fma_f32 v237, -v234, v217, v237
    v_add_f32 v235, v235, v235
    v_mul_f32 v212, v236, v235
    v_mul_f32 v213, v237, v235
    v_mfma_f32_16x16x32_bf16 v[48:51], v[180:183], v[156:159], v[48:51]
    ds_read_b128 v[104:107], v2 offset:32768
    ds_read_b128 v[108:111], v2 offset:33280
    v_mfma_f32_16x16x32_bf16 v[52:55], v[180:183], v[160:163], v[52:55]
    ds_read_b64_tr_b16 v[128:129], v225 offset:32768
    ds_read_b64_tr_b16 v[130:131], v225 offset:33792
    v_mfma_f32_16x16x32_bf16 v[56:59], v[184:187], v[156:159], v[56:59]
    ds_read_b64_tr_b16 v[132:133], v226 offset:32768
    ds_read_b64_tr_b16 v[134:135], v226 offset:33792
    v_mfma_f32_16x16x32_bf16 v[60:63], v[184:187], v[160:163], v[60:63]
    ds_read_b64_tr_b16 v[136:137], v227 offset:32768
    ds_read_b64_tr_b16 v[138:139], v227 offset:33792
    v_mfma_f32_16x16x32_bf16 v[64:67], v[188:191], v[156:159], v[64:67]
    ds_read_b64_tr_b16 v[140:141], v228 offset:32768
    v_mfma_f32_16x16x32_bf16 v[68:71], v[188:191], v[160:163], v[68:71]
    ds_read_b64_tr_b16 v[142:143], v228 offset:33792
    v_mfma_f32_16x16x32_bf16 v[72:75], v[192:195], v[156:159], v[72:75]
    ds_read_b64_tr_b16 v[144:145], v229 offset:32768
    v_mfma_f32_16x16x32_bf16 v[76:79], v[192:195], v[160:163], v[76:79]
    ds_read_b64_tr_b16 v[146:147], v229 offset:33792
    v_mfma_f32_16x16x32_bf16 v[80:83], v[196:199], v[156:159], v[80:83]
    ds_read_b64_tr_b16 v[148:149], v230 offset:32768
    v_mfma_f32_16x16x32_bf16 v[84:87], v[196:199], v[160:163], v[84:87]
    ds_read_b64_tr_b16 v[150:151], v230 offset:33792
    v_mfma_f32_16x16x32_bf16 v[88:91], v[200:203], v[156:159], v[88:91]
    ds_read_b64_tr_b16 v[152:153], v231 offset:32768
    v_mfma_f32_16x16x32_bf16 v[92:95], v[200:203], v[160:163], v[92:95]
    ds_read_b64_tr_b16 v[154:155], v231 offset:33792
    v_mfma_f32_16x16x32_bf16 v[96:99], v[204:207], v[156:159], v[96:99]
    ds_read_b128 v[112:115], v4 offset:16384
    v_mfma_f32_16x16x32_bf16 v[100:103], v[204:207], v[160:163], v[100:103]
    ds_read_b128 v[116:119], v4 offset:18432
    v_mfma_f32_16x16x32_bf16 v[16:19], v[156:159], v[164:167], v[16:19]
    ds_read_b128 v[120:123], v4 offset:20480
    v_mfma_f32_16x16x32_bf16 v[32:35], v[160:163], v[164:167], v[32:35]
    ds_read_b128 v[124:127], v4 offset:22528
    v_mfma_f32_16x16x32_bf16 v[20:23], v[156:159], v[168:171], v[20:23]
    v_mfma_f32_16x16x32_bf16 v[36:39], v[160:163], v[168:171], v[36:39]
    v_mfma_f32_16x16x32_bf16 v[24:27], v[156:159], v[172:175], v[24:27]
    v_mfma_f32_16x16x32_bf16 v[40:43], v[160:163], v[172:175], v[40:43]
    v_mfma_f32_16x16x32_bf16 v[28:31], v[156:159], v[176:179], v[28:31]
    v_mfma_f32_16x16x32_bf16 v[44:47], v[160:163], v[176:179], v[44:47]
    s_waitcnt lgkmcnt(15)
    v_mfma_f32_16x16x32_bf16 v[48:51], v[128:131], v[104:107], v[48:51]
    ds_read_b128 v[156:159], v3 offset:32768
    ds_read_b128 v[160:163], v3 offset:33280
    v_mfma_f32_16x16x32_bf16 v[52:55], v[128:131], v[108:111], v[52:55]
    ds_read_b64_tr_b16 v[180:181], v225 offset:40960
    ds_read_b64_tr_b16 v[182:183], v225 offset:41984
    s_waitcnt lgkmcnt(15)
    v_mfma_f32_16x16x32_bf16 v[56:59], v[132:135], v[104:107], v[56:59]
    ds_read_b64_tr_b16 v[184:185], v226 offset:40960
    ds_read_b64_tr_b16 v[186:187], v226 offset:41984
    v_mfma_f32_16x16x32_bf16 v[60:63], v[132:135], v[108:111], v[60:63]
    ds_read_b64_tr_b16 v[188:189], v227 offset:40960
    ds_read_b64_tr_b16 v[190:191], v227 offset:41984
    s_waitcnt lgkmcnt(15)
    v_mfma_f32_16x16x32_bf16 v[64:67], v[136:139], v[104:107], v[64:67]
    ds_read_b64_tr_b16 v[192:193], v228 offset:40960
    v_mfma_f32_16x16x32_bf16 v[68:71], v[136:139], v[108:111], v[68:71]
    ds_read_b64_tr_b16 v[194:195], v228 offset:41984
    s_waitcnt lgkmcnt(15)
    v_mfma_f32_16x16x32_bf16 v[72:75], v[140:143], v[104:107], v[72:75]
    ds_read_b64_tr_b16 v[196:197], v229 offset:40960
    v_mfma_f32_16x16x32_bf16 v[76:79], v[140:143], v[108:111], v[76:79]
    ds_read_b64_tr_b16 v[198:199], v229 offset:41984
    s_waitcnt lgkmcnt(15)
    v_mfma_f32_16x16x32_bf16 v[80:83], v[144:147], v[104:107], v[80:83]
    ds_read_b64_tr_b16 v[200:201], v230 offset:40960
    v_mfma_f32_16x16x32_bf16 v[84:87], v[144:147], v[108:111], v[84:87]
    ds_read_b64_tr_b16 v[202:203], v230 offset:41984
    s_waitcnt lgkmcnt(15)
    v_mfma_f32_16x16x32_bf16 v[88:91], v[148:151], v[104:107], v[88:91]
    ds_read_b64_tr_b16 v[204:205], v231 offset:40960
    v_mfma_f32_16x16x32_bf16 v[92:95], v[148:151], v[108:111], v[92:95]
    ds_read_b64_tr_b16 v[206:207], v231 offset:41984
    s_waitcnt lgkmcnt(15)
    v_mfma_f32_16x16x32_bf16 v[96:99], v[152:155], v[104:107], v[96:99]
    ds_read_b128 v[164:167], v5 offset:16384
    v_mfma_f32_16x16x32_bf16 v[100:103], v[152:155], v[108:111], v[100:103]
    ds_read_b128 v[168:171], v5 offset:18432
    s_waitcnt lgkmcnt(15)
    v_mfma_f32_16x16x32_bf16 v[16:19], v[104:107], v[112:115], v[16:19]
    ds_read_b128 v[172:175], v5 offset:20480
    v_mfma_f32_16x16x32_bf16 v[32:35], v[108:111], v[112:115], v[32:35]
    ds_read_b128 v[176:179], v5 offset:22528
    s_waitcnt lgkmcnt(15)
    v_mfma_f32_16x16x32_bf16 v[20:23], v[104:107], v[116:119], v[20:23]
    v_mfma_f32_16x16x32_bf16 v[36:39], v[108:111], v[116:119], v[36:39]
    s_waitcnt lgkmcnt(15)
    v_mfma_f32_16x16x32_bf16 v[24:27], v[104:107], v[120:123], v[24:27]
    v_mfma_f32_16x16x32_bf16 v[40:43], v[108:111], v[120:123], v[40:43]
    s_waitcnt lgkmcnt(15)
    v_mfma_f32_16x16x32_bf16 v[28:31], v[104:107], v[124:127], v[28:31]
    v_mfma_f32_16x16x32_bf16 v[44:47], v[108:111], v[124:127], v[44:47]
    s_waitcnt lgkmcnt(0)
    s_barrier
    v_lshlrev_b32 v219, 16, v219
    v_lshlrev_b32 v220, 16, v220
    v_lshlrev_b32 v221, 16, v221
    v_mul_f32 v234, 1069066811, v221
    v_exp_f32 v234, v234
    s_nop 1
    v_cvt_pk_bf16_f32 v234, v234, v234
    v_lshlrev_b32 v234, 16, v234
    v_mul_f32 v235, v234, v219
    v_mul_f32 v236, v234, v220
    v_mul_f32 v235, 1069066811, v235
    v_exp_f32 v235, v235
    v_mul_f32 v236, 1042479491, v236
    v_rndne_f32 v237, v236
    v_sub_f32 v236, v236, v237
    v_cos_f32 v237, v236
    v_sin_f32 v238, v236
    s_nop 1
    v_mul_f32 v210, v235, v237
    v_mul_f32 v211, v235, v238
    v_add_f32 v234, -1.0, v210
    v_mul_f32 v235, v219, v219
    v_fma_f32 v235, v220, v220, v235
    v_rcp_f32 v235, v235
    v_mul_f32 v236, v234, v219
    v_fma_f32 v236, v211, v220, v236
    v_mul_f32 v237, v211, v219
    v_fma_f32 v237, -v234, v220, v237
    v_add_f32 v235, v235, v235
    v_mul_f32 v214, v236, v235
    v_mul_f32 v215, v237, v235
    v_mfma_f32_16x16x32_bf16 v[48:51], v[180:183], v[156:159], v[48:51]
    ds_read_b128 v[104:107], v2 offset:0
    ds_read_b128 v[108:111], v2 offset:512
    v_mfma_f32_16x16x32_bf16 v[52:55], v[180:183], v[160:163], v[52:55]
    ds_read_b64_tr_b16 v[128:129], v225 offset:0
    ds_read_b64_tr_b16 v[130:131], v225 offset:1024
    v_mfma_f32_16x16x32_bf16 v[56:59], v[184:187], v[156:159], v[56:59]
    ds_read_b64_tr_b16 v[132:133], v226 offset:0
    ds_read_b64_tr_b16 v[134:135], v226 offset:1024
    v_mfma_f32_16x16x32_bf16 v[60:63], v[184:187], v[160:163], v[60:63]
    ds_read_b64_tr_b16 v[136:137], v227 offset:0
    ds_read_b64_tr_b16 v[138:139], v227 offset:1024
    v_mfma_f32_16x16x32_bf16 v[64:67], v[188:191], v[156:159], v[64:67]
    ds_read_b64_tr_b16 v[140:141], v228 offset:0
    v_mfma_f32_16x16x32_bf16 v[68:71], v[188:191], v[160:163], v[68:71]
    ds_read_b64_tr_b16 v[142:143], v228 offset:1024
    v_mfma_f32_16x16x32_bf16 v[72:75], v[192:195], v[156:159], v[72:75]
    ds_read_b64_tr_b16 v[144:145], v229 offset:0
    v_mfma_f32_16x16x32_bf16 v[76:79], v[192:195], v[160:163], v[76:79]
    ds_read_b64_tr_b16 v[146:147], v229 offset:1024
    v_mfma_f32_16x16x32_bf16 v[80:83], v[196:199], v[156:159], v[80:83]
    ds_read_b64_tr_b16 v[148:149], v230 offset:0
    v_mfma_f32_16x16x32_bf16 v[84:87], v[196:199], v[160:163], v[84:87]
    ds_read_b64_tr_b16 v[150:151], v230 offset:1024
    v_mfma_f32_16x16x32_bf16 v[88:91], v[200:203], v[156:159], v[88:91]
    ds_read_b64_tr_b16 v[152:153], v231 offset:0
    v_mfma_f32_16x16x32_bf16 v[92:95], v[200:203], v[160:163], v[92:95]
    ds_read_b64_tr_b16 v[154:155], v231 offset:1024
    v_mfma_f32_16x16x32_bf16 v[96:99], v[204:207], v[156:159], v[96:99]
    ds_read_b128 v[112:115], v4 offset:0
    v_mfma_f32_16x16x32_bf16 v[100:103], v[204:207], v[160:163], v[100:103]
    ds_read_b128 v[116:119], v4 offset:2048
    v_mfma_f32_16x16x32_bf16 v[16:19], v[156:159], v[164:167], v[16:19]
    ds_read_b128 v[120:123], v4 offset:4096
    v_mfma_f32_16x16x32_bf16 v[32:35], v[160:163], v[164:167], v[32:35]
    ds_read_b128 v[124:127], v4 offset:6144
    v_mfma_f32_16x16x32_bf16 v[20:23], v[156:159], v[168:171], v[20:23]
    v_mfma_f32_16x16x32_bf16 v[36:39], v[160:163], v[168:171], v[36:39]
    v_mfma_f32_16x16x32_bf16 v[24:27], v[156:159], v[172:175], v[24:27]
    v_mfma_f32_16x16x32_bf16 v[40:43], v[160:163], v[172:175], v[40:43]
    v_mfma_f32_16x16x32_bf16 v[28:31], v[156:159], v[176:179], v[28:31]
    v_mfma_f32_16x16x32_bf16 v[44:47], v[160:163], v[176:179], v[44:47]
    s_waitcnt lgkmcnt(15)
    v_mfma_f32_16x16x32_bf16 v[48:51], v[128:131], v[104:107], v[48:51]
    ds_read_b128 v[156:159], v3 offset:0
    ds_read_b128 v[160:163], v3 offset:512
    v_mfma_f32_16x16x32_bf16 v[52:55], v[128:131], v[108:111], v[52:55]
    ds_read_b64_tr_b16 v[180:181], v225 offset:8192
    ds_read_b64_tr_b16 v[182:183], v225 offset:9216
    s_waitcnt lgkmcnt(15)
    v_mfma_f32_16x16x32_bf16 v[56:59], v[132:135], v[104:107], v[56:59]
    ds_read_b64_tr_b16 v[184:185], v226 offset:8192
    ds_read_b64_tr_b16 v[186:187], v226 offset:9216
    v_mfma_f32_16x16x32_bf16 v[60:63], v[132:135], v[108:111], v[60:63]
    ds_read_b64_tr_b16 v[188:189], v227 offset:8192
    ds_read_b64_tr_b16 v[190:191], v227 offset:9216
    s_waitcnt lgkmcnt(15)
    v_mfma_f32_16x16x32_bf16 v[64:67], v[136:139], v[104:107], v[64:67]
    ds_read_b64_tr_b16 v[192:193], v228 offset:8192
    v_mfma_f32_16x16x32_bf16 v[68:71], v[136:139], v[108:111], v[68:71]
    ds_read_b64_tr_b16 v[194:195], v228 offset:9216
    s_waitcnt lgkmcnt(15)
    v_mfma_f32_16x16x32_bf16 v[72:75], v[140:143], v[104:107], v[72:75]
    ds_read_b64_tr_b16 v[196:197], v229 offset:8192
    v_mfma_f32_16x16x32_bf16 v[76:79], v[140:143], v[108:111], v[76:79]
    ds_read_b64_tr_b16 v[198:199], v229 offset:9216
    s_waitcnt lgkmcnt(15)
    v_mfma_f32_16x16x32_bf16 v[80:83], v[144:147], v[104:107], v[80:83]
    ds_read_b64_tr_b16 v[200:201], v230 offset:8192
    v_mfma_f32_16x16x32_bf16 v[84:87], v[144:147], v[108:111], v[84:87]
    ds_read_b64_tr_b16 v[202:203], v230 offset:9216
    s_waitcnt lgkmcnt(15)
    v_mfma_f32_16x16x32_bf16 v[88:91], v[148:151], v[104:107], v[88:91]
    ds_read_b64_tr_b16 v[204:205], v231 offset:8192
    v_mfma_f32_16x16x32_bf16 v[92:95], v[148:151], v[108:111], v[92:95]
    ds_read_b64_tr_b16 v[206:207], v231 offset:9216
    s_waitcnt lgkmcnt(15)
    v_mfma_f32_16x16x32_bf16 v[96:99], v[152:155], v[104:107], v[96:99]
    ds_read_b128 v[164:167], v5 offset:0
    v_mfma_f32_16x16x32_bf16 v[100:103], v[152:155], v[108:111], v[100:103]
    ds_read_b128 v[168:171], v5 offset:2048
    s_waitcnt lgkmcnt(15)
    v_mfma_f32_16x16x32_bf16 v[16:19], v[104:107], v[112:115], v[16:19]
    ds_read_b128 v[172:175], v5 offset:4096
    v_mfma_f32_16x16x32_bf16 v[32:35], v[108:111], v[112:115], v[32:35]
    ds_read_b128 v[176:179], v5 offset:6144
    s_waitcnt lgkmcnt(15)
    v_mfma_f32_16x16x32_bf16 v[20:23], v[104:107], v[116:119], v[20:23]
    v_mfma_f32_16x16x32_bf16 v[36:39], v[108:111], v[116:119], v[36:39]
    s_waitcnt lgkmcnt(15)
    v_mfma_f32_16x16x32_bf16 v[24:27], v[104:107], v[120:123], v[24:27]
    v_mfma_f32_16x16x32_bf16 v[40:43], v[108:111], v[120:123], v[40:43]
    s_waitcnt lgkmcnt(15)
    v_mfma_f32_16x16x32_bf16 v[28:31], v[104:107], v[124:127], v[28:31]
    v_mfma_f32_16x16x32_bf16 v[44:47], v[108:111], v[124:127], v[44:47]
    s_waitcnt lgkmcnt(0)
    s_barrier
    v_mfma_f32_16x16x32_bf16 v[48:51], v[180:183], v[156:159], v[48:51]
    ds_read_b128 v[104:107], v2 offset:16384
    ds_read_b128 v[108:111], v2 offset:16896
    v_mfma_f32_16x16x32_bf16 v[52:55], v[180:183], v[160:163], v[52:55]
    ds_read_b64_tr_b16 v[128:129], v225 offset:16384
    ds_read_b64_tr_b16 v[130:131], v225 offset:17408
    v_mfma_f32_16x16x32_bf16 v[56:59], v[184:187], v[156:159], v[56:59]
    ds_read_b64_tr_b16 v[132:133], v226 offset:16384
    ds_read_b64_tr_b16 v[134:135], v226 offset:17408
    v_mfma_f32_16x16x32_bf16 v[60:63], v[184:187], v[160:163], v[60:63]
    ds_read_b64_tr_b16 v[136:137], v227 offset:16384
    ds_read_b64_tr_b16 v[138:139], v227 offset:17408
    v_mfma_f32_16x16x32_bf16 v[64:67], v[188:191], v[156:159], v[64:67]
    ds_read_b64_tr_b16 v[140:141], v228 offset:16384
    v_mfma_f32_16x16x32_bf16 v[68:71], v[188:191], v[160:163], v[68:71]
    ds_read_b64_tr_b16 v[142:143], v228 offset:17408
    v_mfma_f32_16x16x32_bf16 v[72:75], v[192:195], v[156:159], v[72:75]
    ds_read_b64_tr_b16 v[144:145], v229 offset:16384
    v_mfma_f32_16x16x32_bf16 v[76:79], v[192:195], v[160:163], v[76:79]
    ds_read_b64_tr_b16 v[146:147], v229 offset:17408
    v_mfma_f32_16x16x32_bf16 v[80:83], v[196:199], v[156:159], v[80:83]
    ds_read_b64_tr_b16 v[148:149], v230 offset:16384
    v_mfma_f32_16x16x32_bf16 v[84:87], v[196:199], v[160:163], v[84:87]
    ds_read_b64_tr_b16 v[150:151], v230 offset:17408
    v_mfma_f32_16x16x32_bf16 v[88:91], v[200:203], v[156:159], v[88:91]
    ds_read_b64_tr_b16 v[152:153], v231 offset:16384
    v_mfma_f32_16x16x32_bf16 v[92:95], v[200:203], v[160:163], v[92:95]
    ds_read_b64_tr_b16 v[154:155], v231 offset:17408
    v_mfma_f32_16x16x32_bf16 v[96:99], v[204:207], v[156:159], v[96:99]
    ds_read_b128 v[112:115], v4 offset:8192
    v_mfma_f32_16x16x32_bf16 v[100:103], v[204:207], v[160:163], v[100:103]
    ds_read_b128 v[116:119], v4 offset:10240
    v_mfma_f32_16x16x32_bf16 v[16:19], v[156:159], v[164:167], v[16:19]
    ds_read_b128 v[120:123], v4 offset:12288
    v_mfma_f32_16x16x32_bf16 v[32:35], v[160:163], v[164:167], v[32:35]
    ds_read_b128 v[124:127], v4 offset:14336
    v_mfma_f32_16x16x32_bf16 v[20:23], v[156:159], v[168:171], v[20:23]
    v_mfma_f32_16x16x32_bf16 v[36:39], v[160:163], v[168:171], v[36:39]
    v_mfma_f32_16x16x32_bf16 v[24:27], v[156:159], v[172:175], v[24:27]
    v_mfma_f32_16x16x32_bf16 v[40:43], v[160:163], v[172:175], v[40:43]
    v_mfma_f32_16x16x32_bf16 v[28:31], v[156:159], v[176:179], v[28:31]
    v_mfma_f32_16x16x32_bf16 v[44:47], v[160:163], v[176:179], v[44:47]
    s_waitcnt lgkmcnt(15)
    v_mfma_f32_16x16x32_bf16 v[48:51], v[128:131], v[104:107], v[48:51]
    ds_read_b128 v[156:159], v3 offset:16384
    ds_read_b128 v[160:163], v3 offset:16896
    v_mfma_f32_16x16x32_bf16 v[52:55], v[128:131], v[108:111], v[52:55]
    ds_read_b64_tr_b16 v[180:181], v225 offset:24576
    ds_read_b64_tr_b16 v[182:183], v225 offset:25600
    s_waitcnt lgkmcnt(15)
    v_mfma_f32_16x16x32_bf16 v[56:59], v[132:135], v[104:107], v[56:59]
    ds_read_b64_tr_b16 v[184:185], v226 offset:24576
    ds_read_b64_tr_b16 v[186:187], v226 offset:25600
    v_mfma_f32_16x16x32_bf16 v[60:63], v[132:135], v[108:111], v[60:63]
    ds_read_b64_tr_b16 v[188:189], v227 offset:24576
    ds_read_b64_tr_b16 v[190:191], v227 offset:25600
    s_waitcnt lgkmcnt(15)
    v_mfma_f32_16x16x32_bf16 v[64:67], v[136:139], v[104:107], v[64:67]
    ds_read_b64_tr_b16 v[192:193], v228 offset:24576
    v_mfma_f32_16x16x32_bf16 v[68:71], v[136:139], v[108:111], v[68:71]
    ds_read_b64_tr_b16 v[194:195], v228 offset:25600
    s_waitcnt lgkmcnt(15)
    v_mfma_f32_16x16x32_bf16 v[72:75], v[140:143], v[104:107], v[72:75]
    ds_read_b64_tr_b16 v[196:197], v229 offset:24576
    v_mfma_f32_16x16x32_bf16 v[76:79], v[140:143], v[108:111], v[76:79]
    ds_read_b64_tr_b16 v[198:199], v229 offset:25600
    s_waitcnt lgkmcnt(15)
    v_mfma_f32_16x16x32_bf16 v[80:83], v[144:147], v[104:107], v[80:83]
    ds_read_b64_tr_b16 v[200:201], v230 offset:24576
    v_mfma_f32_16x16x32_bf16 v[84:87], v[144:147], v[108:111], v[84:87]
    ds_read_b64_tr_b16 v[202:203], v230 offset:25600
    s_waitcnt lgkmcnt(15)
    v_mfma_f32_16x16x32_bf16 v[88:91], v[148:151], v[104:107], v[88:91]
    ds_read_b64_tr_b16 v[204:205], v231 offset:24576
    v_mfma_f32_16x16x32_bf16 v[92:95], v[148:151], v[108:111], v[92:95]
    ds_read_b64_tr_b16 v[206:207], v231 offset:25600
    s_waitcnt lgkmcnt(15)
    v_mfma_f32_16x16x32_bf16 v[96:99], v[152:155], v[104:107], v[96:99]
    ds_read_b128 v[164:167], v5 offset:8192
    v_mfma_f32_16x16x32_bf16 v[100:103], v[152:155], v[108:111], v[100:103]
    ds_read_b128 v[168:171], v5 offset:10240
    s_waitcnt lgkmcnt(15)
    v_mfma_f32_16x16x32_bf16 v[16:19], v[104:107], v[112:115], v[16:19]
    ds_read_b128 v[172:175], v5 offset:12288
    v_mfma_f32_16x16x32_bf16 v[32:35], v[108:111], v[112:115], v[32:35]
    ds_read_b128 v[176:179], v5 offset:14336
    s_waitcnt lgkmcnt(15)
    v_mfma_f32_16x16x32_bf16 v[20:23], v[104:107], v[116:119], v[20:23]
    v_mfma_f32_16x16x32_bf16 v[36:39], v[108:111], v[116:119], v[36:39]
    s_waitcnt lgkmcnt(15)
    v_mfma_f32_16x16x32_bf16 v[24:27], v[104:107], v[120:123], v[24:27]
    v_mfma_f32_16x16x32_bf16 v[40:43], v[108:111], v[120:123], v[40:43]
    s_waitcnt lgkmcnt(15)
    v_mfma_f32_16x16x32_bf16 v[28:31], v[104:107], v[124:127], v[28:31]
    v_mfma_f32_16x16x32_bf16 v[44:47], v[108:111], v[124:127], v[44:47]
    s_waitcnt lgkmcnt(0)
    s_barrier
    v_mfma_f32_16x16x32_bf16 v[48:51], v[180:183], v[156:159], v[48:51]
    ds_read_b128 v[104:107], v2 offset:32768
    ds_read_b128 v[108:111], v2 offset:33280
    v_mfma_f32_16x16x32_bf16 v[52:55], v[180:183], v[160:163], v[52:55]
    ds_read_b64_tr_b16 v[128:129], v225 offset:32768
    ds_read_b64_tr_b16 v[130:131], v225 offset:33792
    v_mfma_f32_16x16x32_bf16 v[56:59], v[184:187], v[156:159], v[56:59]
    ds_read_b64_tr_b16 v[132:133], v226 offset:32768
    ds_read_b64_tr_b16 v[134:135], v226 offset:33792
    v_mfma_f32_16x16x32_bf16 v[60:63], v[184:187], v[160:163], v[60:63]
    ds_read_b64_tr_b16 v[136:137], v227 offset:32768
    ds_read_b64_tr_b16 v[138:139], v227 offset:33792
    v_mfma_f32_16x16x32_bf16 v[64:67], v[188:191], v[156:159], v[64:67]
    ds_read_b64_tr_b16 v[140:141], v228 offset:32768
    v_mfma_f32_16x16x32_bf16 v[68:71], v[188:191], v[160:163], v[68:71]
    ds_read_b64_tr_b16 v[142:143], v228 offset:33792
    v_mfma_f32_16x16x32_bf16 v[72:75], v[192:195], v[156:159], v[72:75]
    ds_read_b64_tr_b16 v[144:145], v229 offset:32768
    v_mfma_f32_16x16x32_bf16 v[76:79], v[192:195], v[160:163], v[76:79]
    ds_read_b64_tr_b16 v[146:147], v229 offset:33792
    v_mfma_f32_16x16x32_bf16 v[80:83], v[196:199], v[156:159], v[80:83]
    ds_read_b64_tr_b16 v[148:149], v230 offset:32768
    v_mfma_f32_16x16x32_bf16 v[84:87], v[196:199], v[160:163], v[84:87]
    ds_read_b64_tr_b16 v[150:151], v230 offset:33792
    v_mfma_f32_16x16x32_bf16 v[88:91], v[200:203], v[156:159], v[88:91]
    ds_read_b64_tr_b16 v[152:153], v231 offset:32768
    v_mfma_f32_16x16x32_bf16 v[92:95], v[200:203], v[160:163], v[92:95]
    ds_read_b64_tr_b16 v[154:155], v231 offset:33792
    v_mfma_f32_16x16x32_bf16 v[96:99], v[204:207], v[156:159], v[96:99]
    ds_read_b128 v[112:115], v4 offset:16384
    v_mfma_f32_16x16x32_bf16 v[100:103], v[204:207], v[160:163], v[100:103]
    ds_read_b128 v[116:119], v4 offset:18432
    v_mfma_f32_16x16x32_bf16 v[16:19], v[156:159], v[164:167], v[16:19]
    ds_read_b128 v[120:123], v4 offset:20480
    v_mfma_f32_16x16x32_bf16 v[32:35], v[160:163], v[164:167], v[32:35]
    ds_read_b128 v[124:127], v4 offset:22528
    v_mfma_f32_16x16x32_bf16 v[20:23], v[156:159], v[168:171], v[20:23]
    v_mfma_f32_16x16x32_bf16 v[36:39], v[160:163], v[168:171], v[36:39]
    v_mfma_f32_16x16x32_bf16 v[24:27], v[156:159], v[172:175], v[24:27]
    v_mfma_f32_16x16x32_bf16 v[40:43], v[160:163], v[172:175], v[40:43]
    v_mfma_f32_16x16x32_bf16 v[28:31], v[156:159], v[176:179], v[28:31]
    v_mfma_f32_16x16x32_bf16 v[44:47], v[160:163], v[176:179], v[44:47]
    s_waitcnt lgkmcnt(15)
    v_mfma_f32_16x16x32_bf16 v[48:51], v[128:131], v[104:107], v[48:51]
    ds_read_b128 v[156:159], v3 offset:32768
    ds_read_b128 v[160:163], v3 offset:33280
    v_mfma_f32_16x16x32_bf16 v[52:55], v[128:131], v[108:111], v[52:55]
    ds_read_b64_tr_b16 v[180:181], v225 offset:40960
    ds_read_b64_tr_b16 v[182:183], v225 offset:41984
    s_waitcnt lgkmcnt(15)
    v_mfma_f32_16x16x32_bf16 v[56:59], v[132:135], v[104:107], v[56:59]
    ds_read_b64_tr_b16 v[184:185], v226 offset:40960
    ds_read_b64_tr_b16 v[186:187], v226 offset:41984
    v_mfma_f32_16x16x32_bf16 v[60:63], v[132:135], v[108:111], v[60:63]
    ds_read_b64_tr_b16 v[188:189], v227 offset:40960
    ds_read_b64_tr_b16 v[190:191], v227 offset:41984
    s_waitcnt lgkmcnt(15)
    v_mfma_f32_16x16x32_bf16 v[64:67], v[136:139], v[104:107], v[64:67]
    ds_read_b64_tr_b16 v[192:193], v228 offset:40960
    v_mfma_f32_16x16x32_bf16 v[68:71], v[136:139], v[108:111], v[68:71]
    ds_read_b64_tr_b16 v[194:195], v228 offset:41984
    s_waitcnt lgkmcnt(15)
    v_mfma_f32_16x16x32_bf16 v[72:75], v[140:143], v[104:107], v[72:75]
    ds_read_b64_tr_b16 v[196:197], v229 offset:40960
    v_mfma_f32_16x16x32_bf16 v[76:79], v[140:143], v[108:111], v[76:79]
    ds_read_b64_tr_b16 v[198:199], v229 offset:41984
    s_waitcnt lgkmcnt(15)
    v_mfma_f32_16x16x32_bf16 v[80:83], v[144:147], v[104:107], v[80:83]
    ds_read_b64_tr_b16 v[200:201], v230 offset:40960
    v_mfma_f32_16x16x32_bf16 v[84:87], v[144:147], v[108:111], v[84:87]
    ds_read_b64_tr_b16 v[202:203], v230 offset:41984
    s_waitcnt lgkmcnt(15)
    v_mfma_f32_16x16x32_bf16 v[88:91], v[148:151], v[104:107], v[88:91]
    ds_read_b64_tr_b16 v[204:205], v231 offset:40960
    v_mfma_f32_16x16x32_bf16 v[92:95], v[148:151], v[108:111], v[92:95]
    ds_read_b64_tr_b16 v[206:207], v231 offset:41984
    s_waitcnt lgkmcnt(15)
    v_mfma_f32_16x16x32_bf16 v[96:99], v[152:155], v[104:107], v[96:99]
    ds_read_b128 v[164:167], v5 offset:16384
    v_mfma_f32_16x16x32_bf16 v[100:103], v[152:155], v[108:111], v[100:103]
    ds_read_b128 v[168:171], v5 offset:18432
    s_waitcnt lgkmcnt(15)
    v_mfma_f32_16x16x32_bf16 v[16:19], v[104:107], v[112:115], v[16:19]
    ds_read_b128 v[172:175], v5 offset:20480
    v_mfma_f32_16x16x32_bf16 v[32:35], v[108:111], v[112:115], v[32:35]
    ds_read_b128 v[176:179], v5 offset:22528
    s_waitcnt lgkmcnt(15)
    v_mfma_f32_16x16x32_bf16 v[20:23], v[104:107], v[116:119], v[20:23]
    v_mfma_f32_16x16x32_bf16 v[36:39], v[108:111], v[116:119], v[36:39]
    s_waitcnt lgkmcnt(15)
    v_mfma_f32_16x16x32_bf16 v[24:27], v[104:107], v[120:123], v[24:27]
    v_mfma_f32_16x16x32_bf16 v[40:43], v[108:111], v[120:123], v[40:43]
    s_waitcnt lgkmcnt(15)
    v_mfma_f32_16x16x32_bf16 v[28:31], v[104:107], v[124:127], v[28:31]
    v_mfma_f32_16x16x32_bf16 v[44:47], v[108:111], v[124:127], v[44:47]
    s_waitcnt lgkmcnt(0)
    s_barrier
    v_mfma_f32_16x16x32_bf16 v[48:51], v[180:183], v[156:159], v[48:51]
    ds_read_b128 v[104:107], v2 offset:0
    ds_read_b128 v[108:111], v2 offset:512
    v_mfma_f32_16x16x32_bf16 v[52:55], v[180:183], v[160:163], v[52:55]
    ds_read_b64_tr_b16 v[128:129], v225 offset:0
    ds_read_b64_tr_b16 v[130:131], v225 offset:1024
    v_mfma_f32_16x16x32_bf16 v[56:59], v[184:187], v[156:159], v[56:59]
    ds_read_b64_tr_b16 v[132:133], v226 offset:0
    ds_read_b64_tr_b16 v[134:135], v226 offset:1024
    v_mfma_f32_16x16x32_bf16 v[60:63], v[184:187], v[160:163], v[60:63]
    ds_read_b64_tr_b16 v[136:137], v227 offset:0
    ds_read_b64_tr_b16 v[138:139], v227 offset:1024
    v_mfma_f32_16x16x32_bf16 v[64:67], v[188:191], v[156:159], v[64:67]
    ds_read_b64_tr_b16 v[140:141], v228 offset:0
    v_mfma_f32_16x16x32_bf16 v[68:71], v[188:191], v[160:163], v[68:71]
    ds_read_b64_tr_b16 v[142:143], v228 offset:1024
    v_mfma_f32_16x16x32_bf16 v[72:75], v[192:195], v[156:159], v[72:75]
    ds_read_b64_tr_b16 v[144:145], v229 offset:0
    v_mfma_f32_16x16x32_bf16 v[76:79], v[192:195], v[160:163], v[76:79]
    ds_read_b64_tr_b16 v[146:147], v229 offset:1024
    v_mfma_f32_16x16x32_bf16 v[80:83], v[196:199], v[156:159], v[80:83]
    ds_read_b64_tr_b16 v[148:149], v230 offset:0
    v_mfma_f32_16x16x32_bf16 v[84:87], v[196:199], v[160:163], v[84:87]
    ds_read_b64_tr_b16 v[150:151], v230 offset:1024
    v_mfma_f32_16x16x32_bf16 v[88:91], v[200:203], v[156:159], v[88:91]
    ds_read_b64_tr_b16 v[152:153], v231 offset:0
    v_mfma_f32_16x16x32_bf16 v[92:95], v[200:203], v[160:163], v[92:95]
    ds_read_b64_tr_b16 v[154:155], v231 offset:1024
    v_mfma_f32_16x16x32_bf16 v[96:99], v[204:207], v[156:159], v[96:99]
    ds_read_b128 v[112:115], v4 offset:0
    v_mfma_f32_16x16x32_bf16 v[100:103], v[204:207], v[160:163], v[100:103]
    ds_read_b128 v[116:119], v4 offset:2048
    v_mfma_f32_16x16x32_bf16 v[16:19], v[156:159], v[164:167], v[16:19]
    ds_read_b128 v[120:123], v4 offset:4096
    v_mfma_f32_16x16x32_bf16 v[32:35], v[160:163], v[164:167], v[32:35]
    ds_read_b128 v[124:127], v4 offset:6144
    v_mfma_f32_16x16x32_bf16 v[20:23], v[156:159], v[168:171], v[20:23]
    v_mfma_f32_16x16x32_bf16 v[36:39], v[160:163], v[168:171], v[36:39]
    v_mfma_f32_16x16x32_bf16 v[24:27], v[156:159], v[172:175], v[24:27]
    v_mfma_f32_16x16x32_bf16 v[40:43], v[160:163], v[172:175], v[40:43]
    v_mfma_f32_16x16x32_bf16 v[28:31], v[156:159], v[176:179], v[28:31]
    v_mfma_f32_16x16x32_bf16 v[44:47], v[160:163], v[176:179], v[44:47]
    s_waitcnt lgkmcnt(15)
    v_mfma_f32_16x16x32_bf16 v[48:51], v[128:131], v[104:107], v[48:51]
    ds_read_b128 v[156:159], v3 offset:0
    ds_read_b128 v[160:163], v3 offset:512
    v_mfma_f32_16x16x32_bf16 v[52:55], v[128:131], v[108:111], v[52:55]
    ds_read_b64_tr_b16 v[180:181], v225 offset:8192
    ds_read_b64_tr_b16 v[182:183], v225 offset:9216
    s_waitcnt lgkmcnt(15)
    v_mfma_f32_16x16x32_bf16 v[56:59], v[132:135], v[104:107], v[56:59]
    ds_read_b64_tr_b16 v[184:185], v226 offset:8192
    ds_read_b64_tr_b16 v[186:187], v226 offset:9216
    v_mfma_f32_16x16x32_bf16 v[60:63], v[132:135], v[108:111], v[60:63]
    ds_read_b64_tr_b16 v[188:189], v227 offset:8192
    ds_read_b64_tr_b16 v[190:191], v227 offset:9216
    s_waitcnt lgkmcnt(15)
    v_mfma_f32_16x16x32_bf16 v[64:67], v[136:139], v[104:107], v[64:67]
    ds_read_b64_tr_b16 v[192:193], v228 offset:8192
    v_mfma_f32_16x16x32_bf16 v[68:71], v[136:139], v[108:111], v[68:71]
    ds_read_b64_tr_b16 v[194:195], v228 offset:9216
    s_waitcnt lgkmcnt(15)
    v_mfma_f32_16x16x32_bf16 v[72:75], v[140:143], v[104:107], v[72:75]
    ds_read_b64_tr_b16 v[196:197], v229 offset:8192
    v_mfma_f32_16x16x32_bf16 v[76:79], v[140:143], v[108:111], v[76:79]
    ds_read_b64_tr_b16 v[198:199], v229 offset:9216
    s_waitcnt lgkmcnt(15)
    v_mfma_f32_16x16x32_bf16 v[80:83], v[144:147], v[104:107], v[80:83]
    ds_read_b64_tr_b16 v[200:201], v230 offset:8192
    v_mfma_f32_16x16x32_bf16 v[84:87], v[144:147], v[108:111], v[84:87]
    ds_read_b64_tr_b16 v[202:203], v230 offset:9216
    s_waitcnt lgkmcnt(15)
    v_mfma_f32_16x16x32_bf16 v[88:91], v[148:151], v[104:107], v[88:91]
    ds_read_b64_tr_b16 v[204:205], v231 offset:8192
    v_mfma_f32_16x16x32_bf16 v[92:95], v[148:151], v[108:111], v[92:95]
    ds_read_b64_tr_b16 v[206:207], v231 offset:9216
    s_waitcnt lgkmcnt(15)
    v_mfma_f32_16x16x32_bf16 v[96:99], v[152:155], v[104:107], v[96:99]
    ds_read_b128 v[164:167], v5 offset:0
    v_mfma_f32_16x16x32_bf16 v[100:103], v[152:155], v[108:111], v[100:103]
    ds_read_b128 v[168:171], v5 offset:2048
    s_waitcnt lgkmcnt(15)
    v_mfma_f32_16x16x32_bf16 v[16:19], v[104:107], v[112:115], v[16:19]
    ds_read_b128 v[172:175], v5 offset:4096
    v_mfma_f32_16x16x32_bf16 v[32:35], v[108:111], v[112:115], v[32:35]
    ds_read_b128 v[176:179], v5 offset:6144
    s_waitcnt lgkmcnt(15)
    v_mfma_f32_16x16x32_bf16 v[20:23], v[104:107], v[116:119], v[20:23]
    v_mfma_f32_16x16x32_bf16 v[36:39], v[108:111], v[116:119], v[36:39]
    s_waitcnt lgkmcnt(15)
    v_mfma_f32_16x16x32_bf16 v[24:27], v[104:107], v[120:123], v[24:27]
    v_mfma_f32_16x16x32_bf16 v[40:43], v[108:111], v[120:123], v[40:43]
    s_waitcnt lgkmcnt(15)
    v_mfma_f32_16x16x32_bf16 v[28:31], v[104:107], v[124:127], v[28:31]
    v_mfma_f32_16x16x32_bf16 v[44:47], v[108:111], v[124:127], v[44:47]
    s_waitcnt lgkmcnt(0)
    s_barrier
    v_mfma_f32_16x16x32_bf16 v[48:51], v[180:183], v[156:159], v[48:51]
    ds_read_b128 v[104:107], v2 offset:16384
    ds_read_b128 v[108:111], v2 offset:16896
    v_mfma_f32_16x16x32_bf16 v[52:55], v[180:183], v[160:163], v[52:55]
    ds_read_b64_tr_b16 v[128:129], v225 offset:16384
    ds_read_b64_tr_b16 v[130:131], v225 offset:17408
    v_mfma_f32_16x16x32_bf16 v[56:59], v[184:187], v[156:159], v[56:59]
    ds_read_b64_tr_b16 v[132:133], v226 offset:16384
    ds_read_b64_tr_b16 v[134:135], v226 offset:17408
    v_mfma_f32_16x16x32_bf16 v[60:63], v[184:187], v[160:163], v[60:63]
    ds_read_b64_tr_b16 v[136:137], v227 offset:16384
    ds_read_b64_tr_b16 v[138:139], v227 offset:17408
    v_mfma_f32_16x16x32_bf16 v[64:67], v[188:191], v[156:159], v[64:67]
    ds_read_b64_tr_b16 v[140:141], v228 offset:16384
    v_mfma_f32_16x16x32_bf16 v[68:71], v[188:191], v[160:163], v[68:71]
    ds_read_b64_tr_b16 v[142:143], v228 offset:17408
    v_mfma_f32_16x16x32_bf16 v[72:75], v[192:195], v[156:159], v[72:75]
    ds_read_b64_tr_b16 v[144:145], v229 offset:16384
    v_mfma_f32_16x16x32_bf16 v[76:79], v[192:195], v[160:163], v[76:79]
    ds_read_b64_tr_b16 v[146:147], v229 offset:17408
    v_mfma_f32_16x16x32_bf16 v[80:83], v[196:199], v[156:159], v[80:83]
    ds_read_b64_tr_b16 v[148:149], v230 offset:16384
    v_mfma_f32_16x16x32_bf16 v[84:87], v[196:199], v[160:163], v[84:87]
    ds_read_b64_tr_b16 v[150:151], v230 offset:17408
    v_mfma_f32_16x16x32_bf16 v[88:91], v[200:203], v[156:159], v[88:91]
    ds_read_b64_tr_b16 v[152:153], v231 offset:16384
    v_mfma_f32_16x16x32_bf16 v[92:95], v[200:203], v[160:163], v[92:95]
    ds_read_b64_tr_b16 v[154:155], v231 offset:17408
    v_mfma_f32_16x16x32_bf16 v[96:99], v[204:207], v[156:159], v[96:99]
    ds_read_b128 v[112:115], v4 offset:8192
    v_mfma_f32_16x16x32_bf16 v[100:103], v[204:207], v[160:163], v[100:103]
    ds_read_b128 v[116:119], v4 offset:10240
    v_mfma_f32_16x16x32_bf16 v[16:19], v[156:159], v[164:167], v[16:19]
    ds_read_b128 v[120:123], v4 offset:12288
    v_mfma_f32_16x16x32_bf16 v[32:35], v[160:163], v[164:167], v[32:35]
    ds_read_b128 v[124:127], v4 offset:14336
    v_mfma_f32_16x16x32_bf16 v[20:23], v[156:159], v[168:171], v[20:23]
    v_mfma_f32_16x16x32_bf16 v[36:39], v[160:163], v[168:171], v[36:39]
    v_mfma_f32_16x16x32_bf16 v[24:27], v[156:159], v[172:175], v[24:27]
    v_mfma_f32_16x16x32_bf16 v[40:43], v[160:163], v[172:175], v[40:43]
    v_mfma_f32_16x16x32_bf16 v[28:31], v[156:159], v[176:179], v[28:31]
    v_mfma_f32_16x16x32_bf16 v[44:47], v[160:163], v[176:179], v[44:47]
    s_waitcnt lgkmcnt(15)
    v_mfma_f32_16x16x32_bf16 v[48:51], v[128:131], v[104:107], v[48:51]
    ds_read_b128 v[156:159], v3 offset:16384
    ds_read_b128 v[160:163], v3 offset:16896
    v_mfma_f32_16x16x32_bf16 v[52:55], v[128:131], v[108:111], v[52:55]
    ds_read_b64_tr_b16 v[180:181], v225 offset:24576
    ds_read_b64_tr_b16 v[182:183], v225 offset:25600
    s_waitcnt lgkmcnt(15)
    v_mfma_f32_16x16x32_bf16 v[56:59], v[132:135], v[104:107], v[56:59]
    ds_read_b64_tr_b16 v[184:185], v226 offset:24576
    ds_read_b64_tr_b16 v[186:187], v226 offset:25600
    v_mfma_f32_16x16x32_bf16 v[60:63], v[132:135], v[108:111], v[60:63]
    ds_read_b64_tr_b16 v[188:189], v227 offset:24576
    ds_read_b64_tr_b16 v[190:191], v227 offset:25600
    s_waitcnt lgkmcnt(15)
    v_mfma_f32_16x16x32_bf16 v[64:67], v[136:139], v[104:107], v[64:67]
    ds_read_b64_tr_b16 v[192:193], v228 offset:24576
    v_mfma_f32_16x16x32_bf16 v[68:71], v[136:139], v[108:111], v[68:71]
    ds_read_b64_tr_b16 v[194:195], v228 offset:25600
    s_waitcnt lgkmcnt(15)
    v_mfma_f32_16x16x32_bf16 v[72:75], v[140:143], v[104:107], v[72:75]
    ds_read_b64_tr_b16 v[196:197], v229 offset:24576
    v_mfma_f32_16x16x32_bf16 v[76:79], v[140:143], v[108:111], v[76:79]
    ds_read_b64_tr_b16 v[198:199], v229 offset:25600
    s_waitcnt lgkmcnt(15)
    v_mfma_f32_16x16x32_bf16 v[80:83], v[144:147], v[104:107], v[80:83]
    ds_read_b64_tr_b16 v[200:201], v230 offset:24576
    v_mfma_f32_16x16x32_bf16 v[84:87], v[144:147], v[108:111], v[84:87]
    ds_read_b64_tr_b16 v[202:203], v230 offset:25600
    s_waitcnt lgkmcnt(15)
    v_mfma_f32_16x16x32_bf16 v[88:91], v[148:151], v[104:107], v[88:91]
    ds_read_b64_tr_b16 v[204:205], v231 offset:24576
    v_mfma_f32_16x16x32_bf16 v[92:95], v[148:151], v[108:111], v[92:95]
    ds_read_b64_tr_b16 v[206:207], v231 offset:25600
    s_waitcnt lgkmcnt(15)
    v_mfma_f32_16x16x32_bf16 v[96:99], v[152:155], v[104:107], v[96:99]
    ds_read_b128 v[164:167], v5 offset:8192
    v_mfma_f32_16x16x32_bf16 v[100:103], v[152:155], v[108:111], v[100:103]
    ds_read_b128 v[168:171], v5 offset:10240
    s_waitcnt lgkmcnt(15)
    v_mfma_f32_16x16x32_bf16 v[16:19], v[104:107], v[112:115], v[16:19]
    ds_read_b128 v[172:175], v5 offset:12288
    v_mfma_f32_16x16x32_bf16 v[32:35], v[108:111], v[112:115], v[32:35]
    ds_read_b128 v[176:179], v5 offset:14336
    s_waitcnt lgkmcnt(15)
    v_mfma_f32_16x16x32_bf16 v[20:23], v[104:107], v[116:119], v[20:23]
    v_mfma_f32_16x16x32_bf16 v[36:39], v[108:111], v[116:119], v[36:39]
    s_waitcnt lgkmcnt(15)
    v_mfma_f32_16x16x32_bf16 v[24:27], v[104:107], v[120:123], v[24:27]
    v_mfma_f32_16x16x32_bf16 v[40:43], v[108:111], v[120:123], v[40:43]
    s_waitcnt lgkmcnt(15)
    v_mfma_f32_16x16x32_bf16 v[28:31], v[104:107], v[124:127], v[28:31]
    v_mfma_f32_16x16x32_bf16 v[44:47], v[108:111], v[124:127], v[44:47]
    s_waitcnt lgkmcnt(0)
    s_barrier
    v_mfma_f32_16x16x32_bf16 v[48:51], v[180:183], v[156:159], v[48:51]
    v_mfma_f32_16x16x32_bf16 v[52:55], v[180:183], v[160:163], v[52:55]
    v_mfma_f32_16x16x32_bf16 v[56:59], v[184:187], v[156:159], v[56:59]
    v_mfma_f32_16x16x32_bf16 v[60:63], v[184:187], v[160:163], v[60:63]
    v_mfma_f32_16x16x32_bf16 v[64:67], v[188:191], v[156:159], v[64:67]
    v_mfma_f32_16x16x32_bf16 v[68:71], v[188:191], v[160:163], v[68:71]
    v_mfma_f32_16x16x32_bf16 v[72:75], v[192:195], v[156:159], v[72:75]
    v_mfma_f32_16x16x32_bf16 v[76:79], v[192:195], v[160:163], v[76:79]
    v_mfma_f32_16x16x32_bf16 v[80:83], v[196:199], v[156:159], v[80:83]
    v_mfma_f32_16x16x32_bf16 v[84:87], v[196:199], v[160:163], v[84:87]
    v_mfma_f32_16x16x32_bf16 v[88:91], v[200:203], v[156:159], v[88:91]
    v_mfma_f32_16x16x32_bf16 v[92:95], v[200:203], v[160:163], v[92:95]
    v_mfma_f32_16x16x32_bf16 v[96:99], v[204:207], v[156:159], v[96:99]
    v_mfma_f32_16x16x32_bf16 v[100:103], v[204:207], v[160:163], v[100:103]
    v_mfma_f32_16x16x32_bf16 v[16:19], v[156:159], v[164:167], v[16:19]
    v_mfma_f32_16x16x32_bf16 v[32:35], v[160:163], v[164:167], v[32:35]
    v_mfma_f32_16x16x32_bf16 v[20:23], v[156:159], v[168:171], v[20:23]
    v_mfma_f32_16x16x32_bf16 v[36:39], v[160:163], v[168:171], v[36:39]
    v_mfma_f32_16x16x32_bf16 v[24:27], v[156:159], v[172:175], v[24:27]
    v_mfma_f32_16x16x32_bf16 v[40:43], v[160:163], v[172:175], v[40:43]
    v_mfma_f32_16x16x32_bf16 v[28:31], v[156:159], v[176:179], v[28:31]
    v_mfma_f32_16x16x32_bf16 v[44:47], v[160:163], v[176:179], v[44:47]
    s_nop 7
    v_fma_f32 v218, v208, v16, v17
    v_fma_f32 v219, v208, v24, v25
    v_fma_f32 v218, -v209, v24, v218
    v_fma_f32 v219, v209, v16, v219
    v_fma_f32 v222, v210, v20, v21
    v_fma_f32 v223, v210, v28, v29
    v_fma_f32 v222, -v211, v28, v222
    v_fma_f32 v223, v211, v20, v223
    v_fma_f32 v216, v208, v218, v18
    v_fma_f32 v217, v208, v219, v26
    v_fma_f32 v216, -v209, v219, v216
    v_fma_f32 v217, v209, v218, v217
    v_fma_f32 v220, v210, v222, v22
    v_fma_f32 v221, v210, v223, v30
    v_fma_f32 v220, -v211, v223, v220
    v_fma_f32 v221, v211, v222, v221
    v_fma_f32 v218, v208, v216, v19
    v_fma_f32 v219, v208, v217, v27
    v_fma_f32 v218, -v209, v217, v218
    v_fma_f32 v219, v209, v216, v219
    v_fma_f32 v222, v210, v220, v23
    v_fma_f32 v223, v210, v221, v31
    v_fma_f32 v222, -v211, v221, v222
    v_fma_f32 v223, v211, v220, v223
    v_fma_f32 v216, v208, v218, v32
    v_fma_f32 v217, v208, v219, v40
    v_fma_f32 v216, -v209, v219, v216
    v_fma_f32 v217, v209, v218, v217
    v_fma_f32 v220, v210, v222, v36
    v_fma_f32 v221, v210, v223, v44
    v_fma_f32 v220, -v211, v223, v220
    v_fma_f32 v221, v211, v222, v221
    v_fma_f32 v218, v208, v216, v33
    v_fma_f32 v219, v208, v217, v41
    v_fma_f32 v218, -v209, v217, v218
    v_fma_f32 v219, v209, v216, v219
    v_fma_f32 v222, v210, v220, v37
    v_fma_f32 v223, v210, v221, v45
    v_fma_f32 v222, -v211, v221, v222
    v_fma_f32 v223, v211, v220, v223
    v_fma_f32 v216, v208, v218, v34
    v_fma_f32 v217, v208, v219, v42
    v_fma_f32 v216, -v209, v219, v216
    v_fma_f32 v217, v209, v218, v217
    v_fma_f32 v220, v210, v222, v38
    v_fma_f32 v221, v210, v223, v46
    v_fma_f32 v220, -v211, v223, v220
    v_fma_f32 v221, v211, v222, v221
    v_fma_f32 v218, v208, v216, v35
    v_fma_f32 v219, v208, v217, v43
    v_fma_f32 v218, -v209, v217, v218
    v_fma_f32 v219, v209, v216, v219
    v_fma_f32 v222, v210, v220, v39
    v_fma_f32 v223, v210, v221, v47
    v_fma_f32 v222, -v211, v221, v222
    v_fma_f32 v223, v211, v220, v223
    s_lshl_b32 s38, s34, 2
    v_add_u32 v1, s38, v14
    v_lshlrev_b32 v1, 8, v1
    v_lshlrev_b32 v12, 3, v13
    v_add_u32 v1, v1, v12
    v_add_u32 v11, 131072, v1
    ds_write_b64 v11, v[218:219]
    ds_write_b64 v11, v[222:223] offset:128
    v_mov_b32 v1, 135180
    v_mov_b32 v12, 1
    s_mov_b64 exec, 1
    ds_add_u32 v1, v12
    s_mov_b64 exec, -1
    v_mov_b32 v1, 135168
    ds_read_b32 v235, v1
    s_mov_b32 s46, 1069066811
    s_mov_b32 s47, 1069066811
    s_lshl_b32 s38, s32, 2
    s_add_u32 s38, s38, s34
    s_mul_i32 s49, s38, 176
    s_mul_i32 s39, s33, 7
    s_add_u32 s48, s49, s39
    s_lshl_b32 s48, s48, 10
    v_lshlrev_b32 v15, 4, v0
    v_pk_mul_f32 v[104:105], v[48:49], s[46:47]
    v_pk_mul_f32 v[106:107], v[50:51], s[46:47]
    v_pk_mul_f32 v[108:109], v[52:53], s[46:47]
    v_pk_mul_f32 v[110:111], v[54:55], s[46:47]
    v_exp_f32 v112, v104
    v_exp_f32 v113, v105
    v_exp_f32 v114, v106
    v_exp_f32 v115, v107
    v_exp_f32 v116, v108
    v_exp_f32 v117, v109
    v_exp_f32 v118, v110
    v_exp_f32 v119, v111
    v_pk_fma_f32 v[120:121], v[112:113], 0.5, 1.0 op_sel_hi:[1,0,0]
    v_pk_fma_f32 v[122:123], v[114:115], 0.5, 1.0 op_sel_hi:[1,0,0]
    v_pk_fma_f32 v[124:125], v[116:117], 0.5, 1.0 op_sel_hi:[1,0,0]
    v_pk_fma_f32 v[126:127], v[118:119], 0.5, 1.0 op_sel_hi:[1,0,0]
    v_pk_fma_f32 v[120:121], v[112:113], v[120:121], 1.0 op_sel_hi:[1,1,0]
    v_pk_fma_f32 v[122:123], v[114:115], v[122:123], 1.0 op_sel_hi:[1,1,0]
    v_pk_fma_f32 v[124:125], v[116:117], v[124:125], 1.0 op_sel_hi:[1,1,0]
    v_pk_fma_f32 v[126:127], v[118:119], v[126:127], 1.0 op_sel_hi:[1,1,0]
    v_rcp_f32 v104, v120
    v_rcp_f32 v105, v121
    v_rcp_f32 v106, v122
    v_rcp_f32 v107, v123
    v_rcp_f32 v108, v124
    v_rcp_f32 v109, v125
    v_rcp_f32 v110, v126
    v_rcp_f32 v111, v127
    v_pk_fma_f32 v[104:105], v[48:49], v[104:105], v[48:49] neg_lo:[1,0,0] neg_hi:[1,0,0]
    v_pk_fma_f32 v[106:107], v[50:51], v[106:107], v[50:51] neg_lo:[1,0,0] neg_hi:[1,0,0]
    v_pk_fma_f32 v[108:109], v[52:53], v[108:109], v[52:53] neg_lo:[1,0,0] neg_hi:[1,0,0]
    v_pk_fma_f32 v[110:111], v[54:55], v[110:111], v[54:55] neg_lo:[1,0,0] neg_hi:[1,0,0]
    v_cvt_pk_bf16_f32 v128, v104, v105
    v_cvt_pk_bf16_f32 v129, v106, v107
    v_cvt_pk_bf16_f32 v130, v108, v109
    v_cvt_pk_bf16_f32 v131, v110, v111
    s_nop 1
    v_permlane16_swap_b32 v128, v130
    v_permlane16_swap_b32 v129, v131
    buffer_store_dwordx4 v[128:131], v15, s[40:43], s48 offen sc1
    s_add_u32 s48, s48, 1024
    v_pk_mul_f32 v[104:105], v[56:57], s[46:47]
    v_pk_mul_f32 v[106:107], v[58:59], s[46:47]
    v_pk_mul_f32 v[108:109], v[60:61], s[46:47]
    v_pk_mul_f32 v[110:111], v[62:63], s[46:47]
    v_exp_f32 v112, v104
    v_exp_f32 v113, v105
    v_exp_f32 v114, v106
    v_exp_f32 v115, v107
    v_exp_f32 v116, v108
    v_exp_f32 v117, v109
    v_exp_f32 v118, v110
    v_exp_f32 v119, v111
    v_pk_fma_f32 v[120:121], v[112:113], 0.5, 1.0 op_sel_hi:[1,0,0]
    v_pk_fma_f32 v[122:123], v[114:115], 0.5, 1.0 op_sel_hi:[1,0,0]
    v_pk_fma_f32 v[124:125], v[116:117], 0.5, 1.0 op_sel_hi:[1,0,0]
    v_pk_fma_f32 v[126:127], v[118:119], 0.5, 1.0 op_sel_hi:[1,0,0]
    v_pk_fma_f32 v[120:121], v[112:113], v[120:121], 1.0 op_sel_hi:[1,1,0]
    v_pk_fma_f32 v[122:123], v[114:115], v[122:123], 1.0 op_sel_hi:[1,1,0]
    v_pk_fma_f32 v[124:125], v[116:117], v[124:125], 1.0 op_sel_hi:[1,1,0]
    v_pk_fma_f32 v[126:127], v[118:119], v[126:127], 1.0 op_sel_hi:[1,1,0]
    v_rcp_f32 v104, v120
    v_rcp_f32 v105, v121
    v_rcp_f32 v106, v122
    v_rcp_f32 v107, v123
    v_rcp_f32 v108, v124
    v_rcp_f32 v109, v125
    v_rcp_f32 v110, v126
    v_rcp_f32 v111, v127
    v_pk_fma_f32 v[104:105], v[56:57], v[104:105], v[56:57] neg_lo:[1,0,0] neg_hi:[1,0,0]
    v_pk_fma_f32 v[106:107], v[58:59], v[106:107], v[58:59] neg_lo:[1,0,0] neg_hi:[1,0,0]
    v_pk_fma_f32 v[108:109], v[60:61], v[108:109], v[60:61] neg_lo:[1,0,0] neg_hi:[1,0,0]
    v_pk_fma_f32 v[110:111], v[62:63], v[110:111], v[62:63] neg_lo:[1,0,0] neg_hi:[1,0,0]
    v_cvt_pk_bf16_f32 v132, v104, v105
    v_cvt_pk_bf16_f32 v133, v106, v107
    v_cvt_pk_bf16_f32 v134, v108, v109
    v_cvt_pk_bf16_f32 v135, v110, v111
    s_nop 1
    v_permlane16_swap_b32 v132, v134
    v_permlane16_swap_b32 v133, v135
    buffer_store_dwordx4 v[132:135], v15, s[40:43], s48 offen sc1
    s_add_u32 s48, s48, 1024
    v_pk_mul_f32 v[104:105], v[64:65], s[46:47]
    v_pk_mul_f32 v[106:107], v[66:67], s[46:47]
    v_pk_mul_f32 v[108:109], v[68:69], s[46:47]
    v_pk_mul_f32 v[110:111], v[70:71], s[46:47]
    v_exp_f32 v112, v104
    v_exp_f32 v113, v105
    v_exp_f32 v114, v106
    v_exp_f32 v115, v107
    v_exp_f32 v116, v108
    v_exp_f32 v117, v109
    v_exp_f32 v118, v110
    v_exp_f32 v119, v111
    v_pk_fma_f32 v[120:121], v[112:113], 0.5, 1.0 op_sel_hi:[1,0,0]
    v_pk_fma_f32 v[122:123], v[114:115], 0.5, 1.0 op_sel_hi:[1,0,0]
    v_pk_fma_f32 v[124:125], v[116:117], 0.5, 1.0 op_sel_hi:[1,0,0]
    v_pk_fma_f32 v[126:127], v[118:119], 0.5, 1.0 op_sel_hi:[1,0,0]
    v_pk_fma_f32 v[120:121], v[112:113], v[120:121], 1.0 op_sel_hi:[1,1,0]
    v_pk_fma_f32 v[122:123], v[114:115], v[122:123], 1.0 op_sel_hi:[1,1,0]
    v_pk_fma_f32 v[124:125], v[116:117], v[124:125], 1.0 op_sel_hi:[1,1,0]
    v_pk_fma_f32 v[126:127], v[118:119], v[126:127], 1.0 op_sel_hi:[1,1,0]
    v_rcp_f32 v104, v120
    v_rcp_f32 v105, v121
    v_rcp_f32 v106, v122
    v_rcp_f32 v107, v123
    v_rcp_f32 v108, v124
    v_rcp_f32 v109, v125
    v_rcp_f32 v110, v126
    v_rcp_f32 v111, v127
    v_pk_fma_f32 v[104:105], v[64:65], v[104:105], v[64:65] neg_lo:[1,0,0] neg_hi:[1,0,0]
    v_pk_fma_f32 v[106:107], v[66:67], v[106:107], v[66:67] neg_lo:[1,0,0] neg_hi:[1,0,0]
    v_pk_fma_f32 v[108:109], v[68:69], v[108:109], v[68:69] neg_lo:[1,0,0] neg_hi:[1,0,0]
    v_pk_fma_f32 v[110:111], v[70:71], v[110:111], v[70:71] neg_lo:[1,0,0] neg_hi:[1,0,0]
    v_cvt_pk_bf16_f32 v128, v104, v105
    v_cvt_pk_bf16_f32 v129, v106, v107
    v_cvt_pk_bf16_f32 v130, v108, v109
    v_cvt_pk_bf16_f32 v131, v110, v111
    s_nop 1
    v_permlane16_swap_b32 v128, v130
    v_permlane16_swap_b32 v129, v131
    buffer_store_dwordx4 v[128:131], v15, s[40:43], s48 offen sc1
    s_add_u32 s48, s48, 1024
    v_pk_mul_f32 v[104:105], v[72:73], s[46:47]
    v_pk_mul_f32 v[106:107], v[74:75], s[46:47]
    v_pk_mul_f32 v[108:109], v[76:77], s[46:47]
    v_pk_mul_f32 v[110:111], v[78:79], s[46:47]
    v_exp_f32 v112, v104
    v_exp_f32 v113, v105
    v_exp_f32 v114, v106
    v_exp_f32 v115, v107
    v_exp_f32 v116, v108
    v_exp_f32 v117, v109
    v_exp_f32 v118, v110
    v_exp_f32 v119, v111
    v_pk_fma_f32 v[120:121], v[112:113], 0.5, 1.0 op_sel_hi:[1,0,0]
    v_pk_fma_f32 v[122:123], v[114:115], 0.5, 1.0 op_sel_hi:[1,0,0]
    v_pk_fma_f32 v[124:125], v[116:117], 0.5, 1.0 op_sel_hi:[1,0,0]
    v_pk_fma_f32 v[126:127], v[118:119], 0.5, 1.0 op_sel_hi:[1,0,0]
    v_pk_fma_f32 v[120:121], v[112:113], v[120:121], 1.0 op_sel_hi:[1,1,0]
    v_pk_fma_f32 v[122:123], v[114:115], v[122:123], 1.0 op_sel_hi:[1,1,0]
    v_pk_fma_f32 v[124:125], v[116:117], v[124:125], 1.0 op_sel_hi:[1,1,0]
    v_pk_fma_f32 v[126:127], v[118:119], v[126:127], 1.0 op_sel_hi:[1,1,0]
    v_rcp_f32 v104, v120
    v_rcp_f32 v105, v121
    v_rcp_f32 v106, v122
    v_rcp_f32 v107, v123
    v_rcp_f32 v108, v124
    v_rcp_f32 v109, v125
    v_rcp_f32 v110, v126
    v_rcp_f32 v111, v127
    v_pk_fma_f32 v[104:105], v[72:73], v[104:105], v[72:73] neg_lo:[1,0,0] neg_hi:[1,0,0]
    v_pk_fma_f32 v[106:107], v[74:75], v[106:107], v[74:75] neg_lo:[1,0,0] neg_hi:[1,0,0]
    v_pk_fma_f32 v[108:109], v[76:77], v[108:109], v[76:77] neg_lo:[1,0,0] neg_hi:[1,0,0]
    v_pk_fma_f32 v[110:111], v[78:79], v[110:111], v[78:79] neg_lo:[1,0,0] neg_hi:[1,0,0]
    v_cvt_pk_bf16_f32 v132, v104, v105
    v_cvt_pk_bf16_f32 v133, v106, v107
    v_cvt_pk_bf16_f32 v134, v108, v109
    v_cvt_pk_bf16_f32 v135, v110, v111
    s_nop 1
    v_permlane16_swap_b32 v132, v134
    v_permlane16_swap_b32 v133, v135
    buffer_store_dwordx4 v[132:135], v15, s[40:43], s48 offen sc1
    s_add_u32 s48, s48, 1024
    v_pk_mul_f32 v[104:105], v[80:81], s[46:47]
    v_pk_mul_f32 v[106:107], v[82:83], s[46:47]
    v_pk_mul_f32 v[108:109], v[84:85], s[46:47]
    v_pk_mul_f32 v[110:111], v[86:87], s[46:47]
    v_exp_f32 v112, v104
    v_exp_f32 v113, v105
    v_exp_f32 v114, v106
    v_exp_f32 v115, v107
    v_exp_f32 v116, v108
    v_exp_f32 v117, v109
    v_exp_f32 v118, v110
    v_exp_f32 v119, v111
    v_pk_fma_f32 v[120:121], v[112:113], 0.5, 1.0 op_sel_hi:[1,0,0]
    v_pk_fma_f32 v[122:123], v[114:115], 0.5, 1.0 op_sel_hi:[1,0,0]
    v_pk_fma_f32 v[124:125], v[116:117], 0.5, 1.0 op_sel_hi:[1,0,0]
    v_pk_fma_f32 v[126:127], v[118:119], 0.5, 1.0 op_sel_hi:[1,0,0]
    v_pk_fma_f32 v[120:121], v[112:113], v[120:121], 1.0 op_sel_hi:[1,1,0]
    v_pk_fma_f32 v[122:123], v[114:115], v[122:123], 1.0 op_sel_hi:[1,1,0]
    v_pk_fma_f32 v[124:125], v[116:117], v[124:125], 1.0 op_sel_hi:[1,1,0]
    v_pk_fma_f32 v[126:127], v[118:119], v[126:127], 1.0 op_sel_hi:[1,1,0]
    v_rcp_f32 v104, v120
    v_rcp_f32 v105, v121
    v_rcp_f32 v106, v122
    v_rcp_f32 v107, v123
    v_rcp_f32 v108, v124
    v_rcp_f32 v109, v125
    v_rcp_f32 v110, v126
    v_rcp_f32 v111, v127
    v_pk_fma_f32 v[104:105], v[80:81], v[104:105], v[80:81] neg_lo:[1,0,0] neg_hi:[1,0,0]
    v_pk_fma_f32 v[106:107], v[82:83], v[106:107], v[82:83] neg_lo:[1,0,0] neg_hi:[1,0,0]
    v_pk_fma_f32 v[108:109], v[84:85], v[108:109], v[84:85] neg_lo:[1,0,0] neg_hi:[1,0,0]
    v_pk_fma_f32 v[110:111], v[86:87], v[110:111], v[86:87] neg_lo:[1,0,0] neg_hi:[1,0,0]
    v_cvt_pk_bf16_f32 v128, v104, v105
    v_cvt_pk_bf16_f32 v129, v106, v107
    v_cvt_pk_bf16_f32 v130, v108, v109
    v_cvt_pk_bf16_f32 v131, v110, v111
    s_nop 1
    v_permlane16_swap_b32 v128, v130
    v_permlane16_swap_b32 v129, v131
    buffer_store_dwordx4 v[128:131], v15, s[40:43], s48 offen sc1
    s_add_u32 s48, s48, 1024
    v_pk_mul_f32 v[104:105], v[88:89], s[46:47]
    v_pk_mul_f32 v[106:107], v[90:91], s[46:47]
    v_pk_mul_f32 v[108:109], v[92:93], s[46:47]
    v_pk_mul_f32 v[110:111], v[94:95], s[46:47]
    v_exp_f32 v112, v104
    v_exp_f32 v113, v105
    v_exp_f32 v114, v106
    v_exp_f32 v115, v107
    v_exp_f32 v116, v108
    v_exp_f32 v117, v109
    v_exp_f32 v118, v110
    v_exp_f32 v119, v111
    v_pk_fma_f32 v[120:121], v[112:113], 0.5, 1.0 op_sel_hi:[1,0,0]
    v_pk_fma_f32 v[122:123], v[114:115], 0.5, 1.0 op_sel_hi:[1,0,0]
    v_pk_fma_f32 v[124:125], v[116:117], 0.5, 1.0 op_sel_hi:[1,0,0]
    v_pk_fma_f32 v[126:127], v[118:119], 0.5, 1.0 op_sel_hi:[1,0,0]
    v_pk_fma_f32 v[120:121], v[112:113], v[120:121], 1.0 op_sel_hi:[1,1,0]
    v_pk_fma_f32 v[122:123], v[114:115], v[122:123], 1.0 op_sel_hi:[1,1,0]
    v_pk_fma_f32 v[124:125], v[116:117], v[124:125], 1.0 op_sel_hi:[1,1,0]
    v_pk_fma_f32 v[126:127], v[118:119], v[126:127], 1.0 op_sel_hi:[1,1,0]
    v_rcp_f32 v104, v120
    v_rcp_f32 v105, v121
    v_rcp_f32 v106, v122
    v_rcp_f32 v107, v123
    v_rcp_f32 v108, v124
    v_rcp_f32 v109, v125
    v_rcp_f32 v110, v126
    v_rcp_f32 v111, v127
    v_pk_fma_f32 v[104:105], v[88:89], v[104:105], v[88:89] neg_lo:[1,0,0] neg_hi:[1,0,0]
    v_pk_fma_f32 v[106:107], v[90:91], v[106:107], v[90:91] neg_lo:[1,0,0] neg_hi:[1,0,0]
    v_pk_fma_f32 v[108:109], v[92:93], v[108:109], v[92:93] neg_lo:[1,0,0] neg_hi:[1,0,0]
    v_pk_fma_f32 v[110:111], v[94:95], v[110:111], v[94:95] neg_lo:[1,0,0] neg_hi:[1,0,0]
    v_cvt_pk_bf16_f32 v132, v104, v105
    v_cvt_pk_bf16_f32 v133, v106, v107
    v_cvt_pk_bf16_f32 v134, v108, v109
    v_cvt_pk_bf16_f32 v135, v110, v111
    s_nop 1
    v_permlane16_swap_b32 v132, v134
    v_permlane16_swap_b32 v133, v135
    buffer_store_dwordx4 v[132:135], v15, s[40:43], s48 offen sc1
    s_add_u32 s48, s48, 1024
    v_mov_b32 v1, 135176
    v_mov_b32 v12, 1
    s_mov_b64 exec, 1
    ds_add_u32 v1, v12
    s_mov_b64 exec, -1
    v_pk_mul_f32 v[104:105], v[96:97], s[46:47]
    v_pk_mul_f32 v[106:107], v[98:99], s[46:47]
    v_pk_mul_f32 v[108:109], v[100:101], s[46:47]
    v_pk_mul_f32 v[110:111], v[102:103], s[46:47]
    v_exp_f32 v112, v104
    v_exp_f32 v113, v105
    v_exp_f32 v114, v106
    v_exp_f32 v115, v107
    v_exp_f32 v116, v108
    v_exp_f32 v117, v109
    v_exp_f32 v118, v110
    v_exp_f32 v119, v111
    v_pk_fma_f32 v[120:121], v[112:113], 0.5, 1.0 op_sel_hi:[1,0,0]
    v_pk_fma_f32 v[122:123], v[114:115], 0.5, 1.0 op_sel_hi:[1,0,0]
    v_pk_fma_f32 v[124:125], v[116:117], 0.5, 1.0 op_sel_hi:[1,0,0]
    v_pk_fma_f32 v[126:127], v[118:119], 0.5, 1.0 op_sel_hi:[1,0,0]
    v_pk_fma_f32 v[120:121], v[112:113], v[120:121], 1.0 op_sel_hi:[1,1,0]
    v_pk_fma_f32 v[122:123], v[114:115], v[122:123], 1.0 op_sel_hi:[1,1,0]
    v_pk_fma_f32 v[124:125], v[116:117], v[124:125], 1.0 op_sel_hi:[1,1,0]
    v_pk_fma_f32 v[126:127], v[118:119], v[126:127], 1.0 op_sel_hi:[1,1,0]
    v_rcp_f32 v104, v120
    v_rcp_f32 v105, v121
    v_rcp_f32 v106, v122
    v_rcp_f32 v107, v123
    v_rcp_f32 v108, v124
    v_rcp_f32 v109, v125
    v_rcp_f32 v110, v126
    v_rcp_f32 v111, v127
    v_pk_fma_f32 v[104:105], v[96:97], v[104:105], v[96:97] neg_lo:[1,0,0] neg_hi:[1,0,0]
    v_pk_fma_f32 v[106:107], v[98:99], v[106:107], v[98:99] neg_lo:[1,0,0] neg_hi:[1,0,0]
    v_pk_fma_f32 v[108:109], v[100:101], v[108:109], v[100:101] neg_lo:[1,0,0] neg_hi:[1,0,0]
    v_pk_fma_f32 v[110:111], v[102:103], v[110:111], v[102:103] neg_lo:[1,0,0] neg_hi:[1,0,0]
    v_cvt_pk_bf16_f32 v128, v104, v105
    v_cvt_pk_bf16_f32 v129, v106, v107
    v_cvt_pk_bf16_f32 v130, v108, v109
    v_cvt_pk_bf16_f32 v131, v110, v111
    s_nop 1
    v_permlane16_swap_b32 v128, v130
    v_permlane16_swap_b32 v129, v131
    buffer_store_dwordx4 v[128:131], v15, s[40:43], s48 offen sc1
    s_add_u32 s48, s48, 1024
    s_waitcnt lgkmcnt(0)
    v_readfirstlane_b32 s69, v235
    v_mul_f32 v216, v212, v16
    v_mul_f32 v217, v212, v24
    v_fma_f32 v216, -v213, v24, v216
    v_fma_f32 v24, v213, v16, v217
    v_mov_b32 v16, v216
    v_mul_f32 v218, v214, v20
    v_mul_f32 v219, v214, v28
    v_fma_f32 v218, -v215, v28, v218
    v_fma_f32 v28, v215, v20, v219
    v_mov_b32 v20, v218
    v_mul_f32 v216, v212, v17
    v_mul_f32 v217, v212, v25
    v_fma_f32 v216, -v213, v25, v216
    v_fma_f32 v25, v213, v17, v217
    v_mov_b32 v17, v216
    v_mul_f32 v218, v214, v21
    v_mul_f32 v219, v214, v29
    v_fma_f32 v218, -v215, v29, v218
    v_fma_f32 v29, v215, v21, v219
    v_mov_b32 v21, v218
    v_mul_f32 v216, v212, v18
    v_mul_f32 v217, v212, v26
    v_fma_f32 v216, -v213, v26, v216
    v_fma_f32 v26, v213, v18, v217
    v_mov_b32 v18, v216
    v_mul_f32 v218, v214, v22
    v_mul_f32 v219, v214, v30
    v_fma_f32 v218, -v215, v30, v218
    v_fma_f32 v30, v215, v22, v219
    v_mov_b32 v22, v218
    v_mul_f32 v216, v212, v19
    v_mul_f32 v217, v212, v27
    v_fma_f32 v216, -v213, v27, v216
    v_fma_f32 v27, v213, v19, v217
    v_mov_b32 v19, v216
    v_mul_f32 v218, v214, v23
    v_mul_f32 v219, v214, v31
    v_fma_f32 v218, -v215, v31, v218
    v_fma_f32 v31, v215, v23, v219
    v_mov_b32 v23, v218
    v_mul_f32 v216, v212, v32
    v_mul_f32 v217, v212, v40
    v_fma_f32 v216, -v213, v40, v216
    v_fma_f32 v40, v213, v32, v217
    v_mov_b32 v32, v216
    v_mul_f32 v218, v214, v36
    v_mul_f32 v219, v214, v44
    v_fma_f32 v218, -v215, v44, v218
    v_fma_f32 v44, v215, v36, v219
    v_mov_b32 v36, v218
    v_mul_f32 v216, v212, v33
    v_mul_f32 v217, v212, v41
    v_fma_f32 v216, -v213, v41, v216
    v_fma_f32 v41, v213, v33, v217
    v_mov_b32 v33, v216
    v_mul_f32 v218, v214, v37
    v_mul_f32 v219, v214, v45
    v_fma_f32 v218, -v215, v45, v218
    v_fma_f32 v45, v215, v37, v219
    v_mov_b32 v37, v218
    v_mul_f32 v216, v212, v34
    v_mul_f32 v217, v212, v42
    v_fma_f32 v216, -v213, v42, v216
    v_fma_f32 v42, v213, v34, v217
    v_mov_b32 v34, v216
    v_mul_f32 v218, v214, v38
    v_mul_f32 v219, v214, v46
    v_fma_f32 v218, -v215, v46, v218
    v_fma_f32 v46, v215, v38, v219
    v_mov_b32 v38, v218
    v_mul_f32 v216, v212, v35
    v_mul_f32 v217, v212, v43
    v_fma_f32 v216, -v213, v43, v216
    v_fma_f32 v43, v213, v35, v217
    v_mov_b32 v35, v216
    v_mul_f32 v218, v214, v39
    v_mul_f32 v219, v214, v47
    v_fma_f32 v218, -v215, v47, v218
    v_fma_f32 v47, v215, v39, v219
    v_mov_b32 v39, v218
    s_mov_b32 s44, s4
    s_and_b32 s45, s5, 0xffff
    s_mov_b32 s46, 2097152
    s_mov_b32 s47, 0x20000
    s_mov_b32 s56, s96
    s_and_b32 s57, s97, 0xffff
    s_mov_b32 s58, 1024
    s_mov_b32 s59, 0x20000
    s_mov_b32 s60, s98
    s_and_b32 s61, s99, 0xffff
    s_mov_b32 s62, 4194304
    s_mov_b32 s63, 0x20000
    s_lshr_b32 s35, s34, 1
    s_and_b32 s36, s34, 1
    s_lshl_b32 s37, s35, 12
    v_add_u32 v178, s37, v15
    v_lshrrev_b32 v1, 1, v14
    v_lshlrev_b32 v1, 3, v1
    v_lshrrev_b32 v12, 2, v13
    v_add_u32 v1, v1, v12
    v_lshlrev_b32 v1, 7, v1
    v_and_b32 v12, 1, v14
    v_lshlrev_b32 v12, 1, v12
    s_lshl_b32 s37, s36, 2
    v_add_u32 v12, s37, v12
    v_lshrrev_b32 v9, 1, v13
    v_and_b32 v9, 1, v9
    v_add_u32 v12, v12, v9
    v_lshrrev_b32 v9, 3, v13
    v_lshlrev_b32 v9, 2, v9
    v_xor_b32 v12, v12, v9
    v_lshlrev_b32 v12, 4, v12
    v_add_u32 v1, v1, v12
    v_and_b32 v12, 1, v13
    v_lshlrev_b32 v12, 3, v12
    v_add_u32 v1, v1, v12
    v_add_u32 v179, 40960, v1
    v_and_b32 v1, 31, v0
    s_lshl_b32 s37, s36, 5
    v_add_u32 v12, s37, v1
    v_lshlrev_b32 v12, 7, v12
    v_add_u32 v12, 40960, v12
    v_lshrrev_b32 v9, 1, v1
    v_and_b32 v9, 7, v9
    v_lshrrev_b32 v10, 5, v0
    v_add_u32 v8, 0, v10
    v_xor_b32 v8, v8, v9
    v_lshlrev_b32 v8, 4, v8
    v_add_u32 v180, v12, v8
    v_add_u32 v8, 2, v10
    v_xor_b32 v8, v8, v9
    v_lshlrev_b32 v8, 4, v8
    v_add_u32 v181, v12, v8
    v_add_u32 v8, 4, v10
    v_xor_b32 v8, v8, v9
    v_lshlrev_b32 v8, 4, v8
    v_add_u32 v182, v12, v8
    v_add_u32 v8, 6, v10
    v_xor_b32 v8, v8, v9
    v_lshlrev_b32 v8, 4, v8
    v_add_u32 v183, v12, v8
    s_lshl_b32 s38, s32, 7
    s_and_b32 s39, s33, 1
    s_lshl_b32 s39, s39, 6
    s_add_u32 s38, s38, s39
    s_lshl_b32 s39, s35, 5
    s_add_u32 s38, s38, s39
    s_lshr_b32 s39, s33, 1
    s_lshl_b32 s39, s39, 6
    s_lshl_b32 s37, s36, 5
    s_add_u32 s39, s39, s37
    v_add_u32 v4, s39, v1
    v_lshlrev_b32 v5, 3, v10
    v_add_u32 v5, s38, v5
    v_lshlrev_b32 v6, 10, v5
    v_lshlrev_b32 v7, 1, v4
    v_add_u32 v6, v6, v7
    s_mov_b32 s67, 0
    buffer_load_ushort v144, v6, s[44:47], s67 offen offset:0
    buffer_load_ushort v145, v6, s[44:47], s67 offen offset:1024
    buffer_load_ushort v146, v6, s[44:47], s67 offen offset:2048
    buffer_load_ushort v147, v6, s[44:47], s67 offen offset:3072
    s_mov_b32 s67, 16384
    buffer_load_ushort v148, v6, s[44:47], s67 offen offset:0
    buffer_load_ushort v149, v6, s[44:47], s67 offen offset:1024
    buffer_load_ushort v150, v6, s[44:47], s67 offen offset:2048
    buffer_load_ushort v151, v6, s[44:47], s67 offen offset:3072
    s_mov_b32 s67, 4096
    buffer_load_ushort v152, v6, s[44:47], s67 offen offset:0
    buffer_load_ushort v153, v6, s[44:47], s67 offen offset:1024
    buffer_load_ushort v154, v6, s[44:47], s67 offen offset:2048
    buffer_load_ushort v155, v6, s[44:47], s67 offen offset:3072
    s_mov_b32 s67, 20480
    buffer_load_ushort v156, v6, s[44:47], s67 offen offset:0
    buffer_load_ushort v157, v6, s[44:47], s67 offen offset:1024
    buffer_load_ushort v158, v6, s[44:47], s67 offen offset:2048
    buffer_load_ushort v159, v6, s[44:47], s67 offen offset:3072
    buffer_load_ushort v176, v7, s[56:59], 0 offen
    v_lshlrev_b32 v177, 11, v5
    v_lshlrev_b32 v7, 2, v4
    v_add_u32 v177, v177, v7
    v_lshlrev_b32 v190, 2, v5
    v_mov_b32 v48, 0
    v_mov_b32 v49, 0
    v_mov_b32 v50, 0
    v_mov_b32 v51, 0
    v_mov_b32 v52, 0
    v_mov_b32 v53, 0
    v_mov_b32 v54, 0
    v_mov_b32 v55, 0
    v_mov_b32 v56, 0
    v_mov_b32 v57, 0
    v_mov_b32 v58, 0
    v_mov_b32 v59, 0
    v_mov_b32 v60, 0
    v_mov_b32 v61, 0
    v_mov_b32 v62, 0
    v_mov_b32 v63, 0
    v_mov_b32 v64, 0
    v_mov_b32 v65, 0
    v_mov_b32 v66, 0
    v_mov_b32 v67, 0
    v_mov_b32 v68, 0
    v_mov_b32 v69, 0
    v_mov_b32 v70, 0
    v_mov_b32 v71, 0
    v_mov_b32 v72, 0
    v_mov_b32 v73, 0
    v_mov_b32 v74, 0
    v_mov_b32 v75, 0
    v_mov_b32 v76, 0
    v_mov_b32 v77, 0
    v_mov_b32 v78, 0
    v_mov_b32 v79, 0
    s_mov_b32 s54, 0
    s_mov_b32 s37, 0
    s_lshl_b32 s38, s32, 2
    s_add_u32 s38, s38, s34
    s_lshl_b32 s50, s38, 4
    s_add_u32 s50, s50, s33
    s_lshl_b32 s50, s50, 2
    v_mov_b32 v9, s69
    v_mov_b32 v10, 0
    s_add_u32 s51, s50, 14942208
    s_lshl_b32 s38, s34, 2
    s_add_u32 s38, s38, 135184
    v_mov_b32 v8, s38
    s_waitcnt vmcnt(17)
    s_mov_b64 exec, 1
    buffer_store_dword v9, v10, s[40:43], s51 offen sc1
    ds_write_b32 v8, v9
    s_mov_b64 exec, -1
    v_mov_b32 v8, 135172
    s_mov_b32 s65, 262144
L_hspin:
    ds_read_b32 v9, v8
    s_waitcnt lgkmcnt(0)
    v_readfirstlane_b32 s38, v9
    s_cmp_lg_u32 s38, 0
    s_cbranch_scc1 L_hspin_ok
    s_sleep 1
    s_sub_u32 s65, s65, 1
    s_cmp_lg_u32 s65, 0
    s_cbranch_scc1 L_hspin
L_hspin_ok:
    ds_read_b64 v[192:193], v11
    ds_read_b64 v[194:195], v11 offset:128
    s_mul_i32 s38, s34, 4608
    s_add_u32 s38, s38, 135424
    v_mul_u32_u24 v4, 72, v13
    v_lshlrev_b32 v9, 3, v14
    v_add_u32 v4, v4, v9
    v_add_u32 v4, s38, v4
    v_lshrrev_b32 v9, 5, v0
    v_lshlrev_b32 v9, 3, v9
    v_lshrrev_b32 v10, 2, v13
    v_add_u32 v9, v9, v10
    v_mul_u32_u24 v9, 72, v9
    v_and_b32 v10, 1, v14
    v_lshlrev_b32 v10, 5, v10
    v_add_u32 v9, v9, v10
    v_and_b32 v10, 3, v13
    v_lshlrev_b32 v10, 3, v10
    v_add_u32 v9, v9, v10
    v_add_u32 v5, s38, v9
    s_waitcnt lgkmcnt(0)
    v_mul_f32 v196, v212, v192
    v_mul_f32 v197, v212, v193
    v_fma_f32 v196, -v213, v193, v196
    v_fma_f32 v193, v213, v192, v197
    v_mov_b32 v192, v196
    v_mul_f32 v196, v214, v194
    v_mul_f32 v197, v214, v195
    v_fma_f32 v196, -v215, v195, v196
    v_fma_f32 v195, v215, v194, v197
    v_mov_b32 v194, v196
    v_fma_f32 v16, v208, v192, v16
    v_fma_f32 v24, v208, v193, v24
    v_fma_f32 v16, -v209, v193, v16
    v_fma_f32 v24, v209, v192, v24
    v_fma_f32 v20, v210, v194, v20
    v_fma_f32 v28, v210, v195, v28
    v_fma_f32 v20, -v211, v195, v20
    v_fma_f32 v28, v211, v194, v28
    v_fma_f32 v17, v208, v16, v17
    v_fma_f32 v25, v208, v24, v25
    v_fma_f32 v17, -v209, v24, v17
    v_fma_f32 v25, v209, v16, v25
    v_fma_f32 v21, v210, v20, v21
    v_fma_f32 v29, v210, v28, v29
    v_fma_f32 v21, -v211, v28, v21
    v_fma_f32 v29, v211, v20, v29
    v_fma_f32 v18, v208, v17, v18
    v_fma_f32 v26, v208, v25, v26
    v_fma_f32 v18, -v209, v25, v18
    v_fma_f32 v26, v209, v17, v26
    v_fma_f32 v22, v210, v21, v22
    v_fma_f32 v30, v210, v29, v30
    v_fma_f32 v22, -v211, v29, v22
    v_fma_f32 v30, v211, v21, v30
    v_fma_f32 v19, v208, v18, v19
    v_fma_f32 v27, v208, v26, v27
    v_fma_f32 v19, -v209, v26, v19
    v_fma_f32 v27, v209, v18, v27
    v_fma_f32 v23, v210, v22, v23
    v_fma_f32 v31, v210, v30, v31
    v_fma_f32 v23, -v211, v30, v23
    v_fma_f32 v31, v211, v22, v31
    v_fma_f32 v32, v208, v19, v32
    v_fma_f32 v40, v208, v27, v40
    v_fma_f32 v32, -v209, v27, v32
    v_fma_f32 v40, v209, v19, v40
    v_fma_f32 v36, v210, v23, v36
    v_fma_f32 v44, v210, v31, v44
    v_fma_f32 v36, -v211, v31, v36
    v_fma_f32 v44, v211, v23, v44
    v_fma_f32 v33, v208, v32, v33
    v_fma_f32 v41, v208, v40, v41
    v_fma_f32 v33, -v209, v40, v33
    v_fma_f32 v41, v209, v32, v41
    v_fma_f32 v37, v210, v36, v37
    v_fma_f32 v45, v210, v44, v45
    v_fma_f32 v37, -v211, v44, v37
    v_fma_f32 v45, v211, v36, v45
    v_fma_f32 v34, v208, v33, v34
    v_fma_f32 v42, v208, v41, v42
    v_fma_f32 v34, -v209, v41, v34
    v_fma_f32 v42, v209, v33, v42
    v_fma_f32 v38, v210, v37, v38
    v_fma_f32 v46, v210, v45, v46
    v_fma_f32 v38, -v211, v45, v38
    v_fma_f32 v46, v211, v37, v46
    v_fma_f32 v35, v208, v34, v35
    v_fma_f32 v43, v208, v42, v43
    v_fma_f32 v35, -v209, v42, v35
    v_fma_f32 v43, v209, v34, v43
    v_fma_f32 v39, v210, v38, v39
    v_fma_f32 v47, v210, v46, v47
    v_fma_f32 v39, -v211, v46, v39
    v_fma_f32 v47, v211, v38, v47
    v_cvt_pk_bf16_f32 v192, v16, v17
    v_cvt_pk_bf16_f32 v193, v18, v19
    ds_write_b64 v4, v[192:193] offset:0
    v_cvt_pk_bf16_f32 v194, v32, v33
    v_cvt_pk_bf16_f32 v195, v34, v35
    ds_write_b64 v4, v[194:195] offset:32
    v_cvt_pk_bf16_f32 v196, v20, v21
    v_cvt_pk_bf16_f32 v197, v22, v23
    ds_write_b64 v4, v[196:197] offset:1152
    v_cvt_pk_bf16_f32 v198, v36, v37
    v_cvt_pk_bf16_f32 v199, v38, v39
    ds_write_b64 v4, v[198:199] offset:1184
    v_cvt_pk_bf16_f32 v200, -v24, -v25
    v_cvt_pk_bf16_f32 v201, -v26, -v27
    ds_write_b64 v4, v[200:201] offset:2304
    v_cvt_pk_bf16_f32 v202, -v40, -v41
    v_cvt_pk_bf16_f32 v203, -v42, -v43
    ds_write_b64 v4, v[202:203] offset:2336
    v_cvt_pk_bf16_f32 v204, -v28, -v29
    v_cvt_pk_bf16_f32 v205, -v30, -v31
    ds_write_b64 v4, v[204:205] offset:3456
    v_cvt_pk_bf16_f32 v206, -v44, -v45
    v_cvt_pk_bf16_f32 v207, -v46, -v47
    ds_write_b64 v4, v[206:207] offset:3488
    s_waitcnt lgkmcnt(0)
    ds_read_b64_tr_b16 v[16:17], v5 offset:0
    ds_read_b64_tr_b16 v[18:19], v5 offset:288
    ds_read_b64_tr_b16 v[20:21], v5 offset:1152
    ds_read_b64_tr_b16 v[22:23], v5 offset:1440
    ds_read_b64_tr_b16 v[24:25], v5 offset:2304
    ds_read_b64_tr_b16 v[26:27], v5 offset:2592
    ds_read_b64_tr_b16 v[28:29], v5 offset:3456
    ds_read_b64_tr_b16 v[30:31], v5 offset:3744
    s_waitcnt lgkmcnt(0)
    s_lshr_b32 s38, s33, 1
    s_lshl_b32 s38, s38, 3
    s_and_b32 s39, s33, 1
    s_lshl_b32 s39, s39, 1
    s_add_u32 s38, s38, s39
    s_add_u32 s38, s38, 112
    s_add_u32 s48, s49, s38
    s_lshl_b32 s48, s48, 10
    buffer_store_dwordx4 v[16:19], v15, s[40:43], s48 offen offset:0 sc1
    buffer_store_dwordx4 v[20:23], v15, s[40:43], s48 offen offset:1024 sc1
    s_add_u32 s48, s48, 4096
    buffer_store_dwordx4 v[24:27], v15, s[40:43], s48 offen offset:0 sc1
    buffer_store_dwordx4 v[28:31], v15, s[40:43], s48 offen offset:1024 sc1
    s_barrier
    v_add_u32 v184, s54, v178
    v_add_u32 v185, s37, v179
    ds_read_b128 v[80:83], v184 offset:0
    ds_read_b64_tr_b16 v[96:97], v185 offset:0
    ds_read_b64_tr_b16 v[98:99], v185 offset:512
    ds_read_b128 v[84:87], v184 offset:1024
    ds_read_b64_tr_b16 v[100:101], v185 offset:2048
    ds_read_b64_tr_b16 v[102:103], v185 offset:2560
    ds_read_b128 v[88:91], v184 offset:2048
    ds_read_b64_tr_b16 v[104:105], v185 offset:4096
    ds_read_b64_tr_b16 v[106:107], v185 offset:4608
    ds_read_b128 v[92:95], v184 offset:3072
    ds_read_b64_tr_b16 v[108:109], v185 offset:6144
    ds_read_b64_tr_b16 v[110:111], v185 offset:6656
    s_add_u32 s54, s54, 8192
    s_cmp_ge_u32 s54, 40960
    s_cselect_b32 s38, 40960, 0
    s_sub_u32 s54, s54, s38
    s_add_u32 s37, s37, 8192
    s_cmp_ge_u32 s37, 90112
    s_cselect_b32 s38, 90112, 0
    s_sub_u32 s37, s37, s38
    v_add_u32 v184, s54, v178
    v_add_u32 v185, s37, v179
    s_mov_b32 s55, 0
L_c1:
    s_waitcnt lgkmcnt(0)
    s_barrier
    v_mfma_f32_32x32x16_bf16 v[48:63], v[80:83], v[96:99], v[48:63]
    ds_read_b128 v[112:115], v184 offset:0
    ds_read_b64_tr_b16 v[128:129], v185 offset:0
    ds_read_b64_tr_b16 v[130:131], v185 offset:512
    ds_read_b128 v[116:119], v184 offset:1024
    v_mfma_f32_32x32x16_bf16 v[48:63], v[84:87], v[100:103], v[48:63]
    ds_read_b64_tr_b16 v[132:133], v185 offset:2048
    ds_read_b64_tr_b16 v[134:135], v185 offset:2560
    ds_read_b128 v[120:123], v184 offset:2048
    ds_read_b64_tr_b16 v[136:137], v185 offset:4096
    v_mfma_f32_32x32x16_bf16 v[48:63], v[88:91], v[104:107], v[48:63]
    ds_read_b64_tr_b16 v[138:139], v185 offset:4608
    ds_read_b128 v[124:127], v184 offset:3072
    ds_read_b64_tr_b16 v[140:141], v185 offset:6144
    ds_read_b64_tr_b16 v[142:143], v185 offset:6656
    v_mfma_f32_32x32x16_bf16 v[48:63], v[92:95], v[108:111], v[48:63]
    s_add_u32 s54, s54, 8192
    s_cmp_ge_u32 s54, 40960
    s_cselect_b32 s38, 40960, 0
    s_sub_u32 s54, s54, s38
    s_add_u32 s37, s37, 8192
    s_cmp_ge_u32 s37, 90112
    s_cselect_b32 s38, 90112, 0
    s_sub_u32 s37, s37, s38
    v_add_u32 v184, s54, v178
    v_add_u32 v185, s37, v179
    s_waitcnt lgkmcnt(0)
    s_barrier
    v_mfma_f32_32x32x16_bf16 v[48:63], v[112:115], v[128:131], v[48:63]
    ds_read_b128 v[80:83], v184 offset:0
    ds_read_b64_tr_b16 v[96:97], v185 offset:0
    ds_read_b64_tr_b16 v[98:99], v185 offset:512
    ds_read_b128 v[84:87], v184 offset:1024
    v_mfma_f32_32x32x16_bf16 v[48:63], v[116:119], v[132:135], v[48:63]
    ds_read_b64_tr_b16 v[100:101], v185 offset:2048
    ds_read_b64_tr_b16 v[102:103], v185 offset:2560
    ds_read_b128 v[88:91], v184 offset:2048
    ds_read_b64_tr_b16 v[104:105], v185 offset:4096
    v_mfma_f32_32x32x16_bf16 v[48:63], v[120:123], v[136:139], v[48:63]
    ds_read_b64_tr_b16 v[106:107], v185 offset:4608
    ds_read_b128 v[92:95], v184 offset:3072
    ds_read_b64_tr_b16 v[108:109], v185 offset:6144
    ds_read_b64_tr_b16 v[110:111], v185 offset:6656
    v_mfma_f32_32x32x16_bf16 v[48:63], v[124:127], v[140:143], v[48:63]
    s_add_u32 s54, s54, 8192
    s_cmp_ge_u32 s54, 40960
    s_cselect_b32 s38, 40960, 0
    s_sub_u32 s54, s54, s38
    s_add_u32 s37, s37, 8192
    s_cmp_ge_u32 s37, 90112
    s_cselect_b32 s38, 90112, 0
    s_sub_u32 s37, s37, s38
    v_add_u32 v184, s54, v178
    v_add_u32 v185, s37, v179
    s_add_u32 s55, s55, 1
    s_cmp_eq_u32 s55, 2
    s_cbranch_scc1 L_hookF
L_c1_cont:
    s_cmp_lt_u32 s55, 13
    s_cbranch_scc1 L_c1
    s_waitcnt lgkmcnt(0)
    s_barrier
    v_mfma_f32_32x32x16_bf16 v[48:63], v[80:83], v[96:99], v[48:63]
    ds_read_b128 v[112:115], v184 offset:0
    ds_read_b64_tr_b16 v[128:129], v185 offset:0
    ds_read_b64_tr_b16 v[130:131], v185 offset:512
    ds_read_b128 v[116:119], v184 offset:1024
    v_mfma_f32_32x32x16_bf16 v[48:63], v[84:87], v[100:103], v[48:63]
    ds_read_b64_tr_b16 v[132:133], v185 offset:2048
    ds_read_b64_tr_b16 v[134:135], v185 offset:2560
    ds_read_b128 v[120:123], v184 offset:2048
    ds_read_b64_tr_b16 v[136:137], v185 offset:4096
    v_mfma_f32_32x32x16_bf16 v[48:63], v[88:91], v[104:107], v[48:63]
    ds_read_b64_tr_b16 v[138:139], v185 offset:4608
    ds_read_b128 v[124:127], v184 offset:3072
    ds_read_b64_tr_b16 v[140:141], v185 offset:6144
    ds_read_b64_tr_b16 v[142:143], v185 offset:6656
    v_mfma_f32_32x32x16_bf16 v[48:63], v[92:95], v[108:111], v[48:63]
    s_add_u32 s54, s54, 8192
    s_cmp_ge_u32 s54, 40960
    s_cselect_b32 s38, 40960, 0
    s_sub_u32 s54, s54, s38
    s_add_u32 s37, s37, 8192
    s_cmp_ge_u32 s37, 90112
    s_cselect_b32 s38, 90112, 0
    s_sub_u32 s37, s37, s38
    v_add_u32 v184, s54, v178
    v_add_u32 v186, s37, v180
    v_add_u32 v187, s37, v181
    v_add_u32 v188, s37, v182
    v_add_u32 v189, s37, v183
    s_waitcnt lgkmcnt(0)
    s_barrier
    v_mfma_f32_32x32x16_bf16 v[48:63], v[112:115], v[128:131], v[48:63]
    ds_read_b128 v[80:83], v184 offset:0
    ds_read_b128 v[96:99], v186
    ds_read_b128 v[84:87], v184 offset:1024
    ds_read_b128 v[100:103], v187
    v_mfma_f32_32x32x16_bf16 v[48:63], v[116:119], v[132:135], v[48:63]
    ds_read_b128 v[88:91], v184 offset:2048
    ds_read_b128 v[104:107], v188
    ds_read_b128 v[92:95], v184 offset:3072
    ds_read_b128 v[108:111], v189
    v_mfma_f32_32x32x16_bf16 v[48:63], v[120:123], v[136:139], v[48:63]
    v_mfma_f32_32x32x16_bf16 v[48:63], v[124:127], v[140:143], v[48:63]
    s_add_u32 s54, s54, 8192
    s_cmp_ge_u32 s54, 40960
    s_cselect_b32 s38, 40960, 0
    s_sub_u32 s54, s54, s38
    s_add_u32 s37, s37, 8192
    s_cmp_ge_u32 s37, 90112
    s_cselect_b32 s38, 90112, 0
    s_sub_u32 s37, s37, s38
    v_add_u32 v184, s54, v178
    v_add_u32 v186, s37, v180
    v_add_u32 v187, s37, v181
    v_add_u32 v188, s37, v182
    v_add_u32 v189, s37, v183
    s_mov_b32 s66, 14680064
    buffer_load_dwordx4 v[160:163], v190, s[40:43], s66 offen offset:0 sc1
    buffer_load_dwordx4 v[164:167], v190, s[40:43], s66 offen offset:64 sc1
    buffer_load_dwordx4 v[168:171], v190, s[40:43], s66 offen offset:16 sc1
    buffer_load_dwordx4 v[172:175], v190, s[40:43], s66 offen offset:80 sc1
    s_mov_b32 s55, 7
L_c2:
    s_waitcnt lgkmcnt(0)
    s_barrier
    v_mfma_f32_32x32x16_bf16 v[64:79], v[80:83], v[96:99], v[64:79]
    ds_read_b128 v[112:115], v184 offset:0
    ds_read_b128 v[128:131], v186
    ds_read_b128 v[116:119], v184 offset:1024
    ds_read_b128 v[132:135], v187
    v_mfma_f32_32x32x16_bf16 v[64:79], v[84:87], v[100:103], v[64:79]
    ds_read_b128 v[120:123], v184 offset:2048
    ds_read_b128 v[136:139], v188
    ds_read_b128 v[124:127], v184 offset:3072
    ds_read_b128 v[140:143], v189
    v_mfma_f32_32x32x16_bf16 v[64:79], v[88:91], v[104:107], v[64:79]
    v_mfma_f32_32x32x16_bf16 v[64:79], v[92:95], v[108:111], v[64:79]
    s_add_u32 s54, s54, 8192
    s_cmp_ge_u32 s54, 40960
    s_cselect_b32 s38, 40960, 0
    s_sub_u32 s54, s54, s38
    s_add_u32 s37, s37, 8192
    s_cmp_ge_u32 s37, 90112
    s_cselect_b32 s38, 90112, 0
    s_sub_u32 s37, s37, s38
    v_add_u32 v184, s54, v178
    v_add_u32 v186, s37, v180
    v_add_u32 v187, s37, v181
    v_add_u32 v188, s37, v182
    v_add_u32 v189, s37, v183
    s_waitcnt lgkmcnt(0)
    s_barrier
    v_mfma_f32_32x32x16_bf16 v[64:79], v[112:115], v[128:131], v[64:79]
    ds_read_b128 v[80:83], v184 offset:0
    ds_read_b128 v[96:99], v186
    ds_read_b128 v[84:87], v184 offset:1024
    ds_read_b128 v[100:103], v187
    v_mfma_f32_32x32x16_bf16 v[64:79], v[116:119], v[132:135], v[64:79]
    ds_read_b128 v[88:91], v184 offset:2048
    ds_read_b128 v[104:107], v188
    ds_read_b128 v[92:95], v184 offset:3072
    ds_read_b128 v[108:111], v189
    v_mfma_f32_32x32x16_bf16 v[64:79], v[120:123], v[136:139], v[64:79]
    v_mfma_f32_32x32x16_bf16 v[64:79], v[124:127], v[140:143], v[64:79]
    s_add_u32 s54, s54, 8192
    s_cmp_ge_u32 s54, 40960
    s_cselect_b32 s38, 40960, 0
    s_sub_u32 s54, s54, s38
    s_add_u32 s37, s37, 8192
    s_cmp_ge_u32 s37, 90112
    s_cselect_b32 s38, 90112, 0
    s_sub_u32 s37, s37, s38
    v_add_u32 v184, s54, v178
    v_add_u32 v186, s37, v180
    v_add_u32 v187, s37, v181
    v_add_u32 v188, s37, v182
    v_add_u32 v189, s37, v183
    s_sub_u32 s55, s55, 1
    s_cmp_eq_u32 s55, 4
    s_cbranch_scc1 L_hookW
L_c2_cont:
    s_cmp_lg_u32 s55, 0
    s_cbranch_scc1 L_c2
    s_waitcnt lgkmcnt(0)
    s_barrier
    v_mfma_f32_32x32x16_bf16 v[64:79], v[80:83], v[96:99], v[64:79]
    ds_read_b128 v[112:115], v184 offset:0
    ds_read_b128 v[128:131], v186
    ds_read_b128 v[116:119], v184 offset:1024
    ds_read_b128 v[132:135], v187
    v_mfma_f32_32x32x16_bf16 v[64:79], v[84:87], v[100:103], v[64:79]
    ds_read_b128 v[120:123], v184 offset:2048
    ds_read_b128 v[136:139], v188
    ds_read_b128 v[124:127], v184 offset:3072
    ds_read_b128 v[140:143], v189
    v_mfma_f32_32x32x16_bf16 v[64:79], v[88:91], v[104:107], v[64:79]
    v_mfma_f32_32x32x16_bf16 v[64:79], v[92:95], v[108:111], v[64:79]
    s_waitcnt lgkmcnt(0)
    v_mfma_f32_32x32x16_bf16 v[64:79], v[112:115], v[128:131], v[64:79]
    v_mfma_f32_32x32x16_bf16 v[64:79], v[116:119], v[132:135], v[64:79]
    v_mfma_f32_32x32x16_bf16 v[64:79], v[120:123], v[136:139], v[64:79]
    v_mfma_f32_32x32x16_bf16 v[64:79], v[124:127], v[140:143], v[64:79]
    s_nop 15
    v_fma_f32 v64, v160, v64, v48
    v_fma_f32 v65, v161, v65, v49
    v_fma_f32 v66, v162, v66, v50
    v_fma_f32 v67, v163, v67, v51
    v_fma_f32 v68, v164, v68, v52
    v_fma_f32 v69, v165, v69, v53
    v_fma_f32 v70, v166, v70, v54
    v_fma_f32 v71, v167, v71, v55
    v_fma_f32 v72, v168, v72, v56
    v_fma_f32 v73, v169, v73, v57
    v_fma_f32 v74, v170, v74, v58
    v_fma_f32 v75, v171, v75, v59
    v_fma_f32 v76, v172, v76, v60
    v_fma_f32 v77, v173, v77, v61
    v_fma_f32 v78, v174, v78, v62
    v_fma_f32 v79, v175, v79, v63
    s_mov_b32 s67, 0
    buffer_store_dword v64, v177, s[60:63], s67 offen offset:0 nt
    buffer_store_dword v65, v177, s[60:63], s67 offen offset:2048 nt
    s_mov_b32 s67, 4096
    buffer_store_dword v66, v177, s[60:63], s67 offen offset:0 nt
    buffer_store_dword v67, v177, s[60:63], s67 offen offset:2048 nt
    s_mov_b32 s67, 32768
    buffer_store_dword v68, v177, s[60:63], s67 offen offset:0 nt
    buffer_store_dword v69, v177, s[60:63], s67 offen offset:2048 nt
    s_mov_b32 s67, 36864
    buffer_store_dword v70, v177, s[60:63], s67 offen offset:0 nt
    buffer_store_dword v71, v177, s[60:63], s67 offen offset:2048 nt
    s_mov_b32 s67, 8192
    buffer_store_dword v72, v177, s[60:63], s67 offen offset:0 nt
    buffer_store_dword v73, v177, s[60:63], s67 offen offset:2048 nt
    s_mov_b32 s67, 12288
    buffer_store_dword v74, v177, s[60:63], s67 offen offset:0 nt
    buffer_store_dword v75, v177, s[60:63], s67 offen offset:2048 nt
    s_mov_b32 s67, 40960
    buffer_store_dword v76, v177, s[60:63], s67 offen offset:0 nt
    buffer_store_dword v77, v177, s[60:63], s67 offen offset:2048 nt
    s_mov_b32 s67, 45056
    buffer_store_dword v78, v177, s[60:63], s67 offen offset:0 nt
    buffer_store_dword v79, v177, s[60:63], s67 offen offset:2048 nt
    s_endpgm
L_hookW:
    s_waitcnt vmcnt(0)
    v_lshlrev_b32 v176, 16, v176
    v_lshlrev_b32 v144, 16, v144
    v_lshlrev_b32 v145, 16, v145
    v_lshlrev_b32 v146, 16, v146
    v_lshlrev_b32 v147, 16, v147
    v_lshlrev_b32 v148, 16, v148
    v_lshlrev_b32 v149, 16, v149
    v_lshlrev_b32 v150, 16, v150
    v_lshlrev_b32 v151, 16, v151
    v_lshlrev_b32 v152, 16, v152
    v_lshlrev_b32 v153, 16, v153
    v_lshlrev_b32 v154, 16, v154
    v_lshlrev_b32 v155, 16, v155
    v_lshlrev_b32 v156, 16, v156
    v_lshlrev_b32 v157, 16, v157
    v_lshlrev_b32 v158, 16, v158
    v_lshlrev_b32 v159, 16, v159
    v_fma_f32 v144, v144, v176, -v48
    v_fma_f32 v145, v145, v176, -v49
    v_fma_f32 v146, v146, v176, -v50
    v_fma_f32 v147, v147, v176, -v51
    v_fma_f32 v148, v148, v176, -v52
    v_fma_f32 v149, v149, v176, -v53
    v_fma_f32 v150, v150, v176, -v54
    v_fma_f32 v151, v151, v176, -v55
    v_fma_f32 v152, v152, v176, -v56
    v_fma_f32 v153, v153, v176, -v57
    v_fma_f32 v154, v154, v176, -v58
    v_fma_f32 v155, v155, v176, -v59
    v_fma_f32 v156, v156, v176, -v60
    v_fma_f32 v157, v157, v176, -v61
    v_fma_f32 v158, v158, v176, -v62
    v_fma_f32 v159, v159, v176, -v63
    v_fma_f32 v48, v160, v144, v48
    v_fma_f32 v49, v161, v145, v49
    v_fma_f32 v50, v162, v146, v50
    v_fma_f32 v51, v163, v147, v51
    v_fma_f32 v52, v164, v148, v52
    v_fma_f32 v53, v165, v149, v53
    v_fma_f32 v54, v166, v150, v54
    v_fma_f32 v55, v167, v151, v55
    v_fma_f32 v56, v168, v152, v56
    v_fma_f32 v57, v169, v153, v57
    v_fma_f32 v58, v170, v154, v58
    v_fma_f32 v59, v171, v155, v59
    v_fma_f32 v60, v172, v156, v60
    v_fma_f32 v61, v173, v157, v61
    v_fma_f32 v62, v174, v158, v62
    v_fma_f32 v63, v175, v159, v63
    s_branch L_c2_cont
L_hookF:
    s_add_u32 s51, s50, 15073280
    v_mov_b32 v9, s69
    v_mov_b32 v10, 0
    s_waitcnt vmcnt(0)
    s_mov_b64 s[52:53], exec
    s_mov_b64 exec, 1
    buffer_store_dword v9, v10, s[40:43], s51 offen sc1
    s_mov_b64 exec, s[52:53]
    s_branch L_c1_cont
L_end:
    s_endpgm
.section .rodata,"a"
.p2align 6
.amdhsa_kernel gated_mix__ssm_conv_s5__dense_activation_mish__prompt_kernel
  .amdhsa_next_free_vgpr 240
  .amdhsa_next_free_sgpr 102
  .amdhsa_accum_offset 240
  .amdhsa_group_segment_fixed_size 0
  .amdhsa_kernarg_size 136
  .amdhsa_user_sgpr_count 2
  .amdhsa_user_sgpr_kernarg_segment_ptr 1
  .amdhsa_system_sgpr_workgroup_id_x 1
  .amdhsa_float_denorm_mode_32 3
.end_amdhsa_kernel
```
